```python
import torch

def _softmax(x, axis=-1):
    return torch.softmax(x, dim=axis)
def _gelu(x):
    return torch.nn.functional.gelu(x, approximate="tanh")
def _silu(x):
    return torch.nn.functional.silu(x)
def _sigmoid(x):
    return torch.sigmoid(x)
def _layernorm(x, axis=-1, eps=1e-5):
    m = x.mean(dim=axis, keepdim=True)
    v = x.var(dim=axis, keepdim=True, unbiased=False)
    return (x - m) / torch.sqrt(v + eps)
def _scatter_add(tgt, idx, src, axis=0):
    return tgt.clone().index_add_(axis, idx, src)
def _segment_sum(src, seg, n):
    out = torch.zeros((n,) + src.shape[1:], dtype=src.dtype)
    return out.index_add_(0, seg, src)
def _pad(x, pw):
    flat = tuple(v for pair in reversed(pw) for v in pair)
    return torch.nn.functional.pad(x, flat)

kernel_name = 'gated_mix__softmax_full_mha__mixer_token_mlp__prompt'

def setup_inputs():

    _w = (lambda a: (lambda t: t.to(torch.bfloat16) if t.is_floating_point() else t)(torch.as_tensor(a)))
    def _A_setup():
        B, S, D = 1, 2048, 512
        return {
            "x": _w((lambda *s: torch.randn(*s, dtype=torch.bfloat16) * 0.05)(B, S, D)),
            "wqkv": _w((lambda *s: torch.randn(*s, dtype=torch.bfloat16) * 0.8)(D, 3 * D)),
            "wo": _w((lambda *s: torch.randn(*s, dtype=torch.bfloat16) * 0.05)(D, D)),
        }
    _A_in = _A_setup()

    def _B_setup():
        B, S, D, F = 1, 2048, 512, 1376
        return {
            "x": _w((lambda *s: torch.randn(*s, dtype=torch.bfloat16) * 0.05)(B, S, D)),
            "w1": _w((lambda *s: torch.randn(*s, dtype=torch.bfloat16) * 0.8)(S, F) * (S ** -0.5)),
            "b1": _w((lambda *s: torch.randn(*s, dtype=torch.bfloat16) * 12.8)(F) * 0.02),
            "w2": _w((lambda *s: torch.randn(*s, dtype=torch.bfloat16) * 0.05)(F, S) * (F ** -0.5)),
            "b2": _w((lambda *s: torch.randn(*s, dtype=torch.bfloat16) * 0.8)(S) * 0.02),
        }
    _B_in = _B_setup()

    return {
        "A_x": _A_in["x"],
        "A_wqkv": _A_in["wqkv"],
        "A_wo": _A_in["wo"],
        "B_x": _B_in["x"],
        "B_w1": _B_in["w1"],
        "B_b1": _B_in["b1"],
        "B_w2": _B_in["w2"],
        "B_b2": _B_in["b2"],
        "gate_w": _w((lambda *s: torch.randn(*s, dtype=torch.bfloat16) * 0.05)(512) * 16.0),
    }

def reference(A_x, A_wqkv, A_wo, B_x, B_w1, B_b1, B_w2, B_b2, gate_w):
    def _A_ref(x, wqkv, wo):
        B, S, D = x.shape
        H = 32; Dh = D // H
        qkv = (lambda x, *d: x.permute(*d))((x @ wqkv).reshape(B, S, 3, H, Dh), 2, 0, 3, 1, 4)
        q, k, v = qkv[0], qkv[1], qkv[2]
        scale = Dh ** -0.5
        scores = torch.einsum("bhqd,bhkd->bhqk", q, k) * scale
        p = _softmax(scores, axis=-1)
        o = torch.einsum("bhqk,bhkd->bhqd", p, v)
        return (lambda x, *d: x.permute(*d))(o, 0, 2, 1, 3).reshape(B, S, D) @ wo

    def _B_ref(x, w1, b1, w2, b2):
        B, S, D = x.shape
        h = _layernorm(x, axis=-1)
        u = torch.einsum("bsd,sf->bdf", h, w1) + b1
        u = _gelu(u)
        y = torch.einsum("bdf,fs->bds", u, w2) + b2
        return (lambda x, *d: x.permute(*d))(y, 0, 2, 1)

    x = A_x
    g = _sigmoid((x * gate_w).sum(-1, keepdims=True))
    a = _A_ref(x, A_wqkv, A_wo)
    b = _B_ref(x, B_w1, B_b1, B_w2, B_b2)
    return g * a + (1 - g) * b
```

```asm
; @launch grid=(256,1,1) block=(768,1,1) lds=163840
.amdgcn_target "amdgcn-amd-amdhsa--gfx950"
.text
.globl gated_mix__softmax_full_mha__mixer_token_mlp__prompt_kernel
.p2align 8
.type gated_mix__softmax_full_mha__mixer_token_mlp__prompt_kernel,@function
gated_mix__softmax_full_mha__mixer_token_mlp__prompt_kernel:
    s_cmp_ge_u32 s2, 256
    s_cbranch_scc1 END
    s_load_dwordx16 s[4:19], s[0:1], 0
    s_load_dwordx8 s[20:27], s[0:1], 64
    v_lshrrev_b32 v2, 6, v0
    v_and_b32 v1, 63, v0
    v_readfirstlane_b32 s3, v2
    s_and_b32 s52, s2, 7
    s_lshr_b32 s53, s2, 3
    s_mul_i32 s55, s53, 43
    s_lshr_b32 s55, s55, 8
    s_mul_i32 s56, s55, 6
    s_sub_u32 s56, s53, s56
    s_lshl_b32 s58, s55, 1
    s_add_u32 s58, s58, s56
    s_lshr_b32 s54, s52, 1
    s_lshl_b32 s54, s54, 2
    s_add_u32 s54, s54, s55
    s_and_b32 s55, s52, 1
    s_mul_i32 s55, s55, 6
    s_add_u32 s55, s55, s56
    s_cmp_ge_u32 s3, 8
    s_cbranch_scc1 P1_M
    s_cmp_ge_u32 s53, 24
    s_cbranch_scc1 SVC
    s_cmp_ge_u32 s3, 4
    s_cbranch_scc1 P1_LOAD
    s_and_b32 s56, s3, 1
    s_lshr_b32 s57, s3, 1
    s_lshl_b32 s59, s56, 13
    v_and_b32 v2, 31, v1
    v_lshrrev_b32 v3, 5, v1
    v_bfe_u32 v9, v1, 1, 3
    v_lshlrev_b32 v2, 7, v2
    v_add_u32 v2, s59, v2
    v_add_u32 v30, 0, v3
    v_xor_b32 v30, v30, v9
    v_lshl_add_u32 v10, v30, 4, v2
    v_add_u32 v14, 65536, v10
    v_add_u32 v30, 2, v3
    v_xor_b32 v30, v30, v9
    v_lshl_add_u32 v11, v30, 4, v2
    v_add_u32 v15, 65536, v11
    v_add_u32 v30, 4, v3
    v_xor_b32 v30, v30, v9
    v_lshl_add_u32 v12, v30, 4, v2
    v_add_u32 v16, 65536, v12
    v_add_u32 v30, 6, v3
    v_xor_b32 v30, v30, v9
    v_lshl_add_u32 v13, v30, 4, v2
    v_add_u32 v17, 65536, v13
    s_lshl_b32 s59, s57, 13
    s_add_u32 s59, s59, 16384
    s_mov_b32 s60, 0
    v_lshrrev_b32 v2, 5, v1
    v_mul_u32_u24 v2, 8, v2
    v_bfe_u32 v9, v1, 2, 2
    v_add_u32 v2, v2, v9
    v_lshlrev_b32 v2, 7, v2
    v_bfe_u32 v9, v1, 3, 1
    v_lshl_add_u32 v2, v9, 6, v2
    v_bfe_u32 v9, v1, 4, 1
    v_lshl_add_u32 v2, v9, 5, v2
    v_and_b32 v9, 3, v1
    v_lshl_add_u32 v2, v9, 3, v2
    v_xor_b32 v2, s60, v2
    v_add_u32 v18, s59, v2
    v_xor_b32 v2, 64, v2
    v_add_u32 v19, s59, v2
    v_add_u32 v20, 65536, v18
    v_add_u32 v21, 65536, v19
    s_and_b32 s59, s55, 3
    s_lshl_b32 s59, s59, 1
    s_add_u32 s59, s59, s57
    s_lshl_b32 s60, s54, 1
    s_add_u32 s60, s60, s56
    s_lshr_b32 s61, s55, 2
    s_lshl_b32 s62, s61, 8
    s_lshl_b32 s63, s59, 5
    s_add_u32 s62, s62, s63
    s_add_u32 s62, s62, s60
    s_lshl_b32 s62, s62, 7
    s_add_u32 s62, s62, 131072
    s_lshl_b32 s63, s59, 18
    s_lshl_b32 s64, s60, 11
    s_add_u32 s63, s63, s64
    s_lshl_b32 s64, s63, 1
    s_add_u32 s64, s64, 2097152
    s_cmp_eq_u32 s61, 0
    s_cselect_b32 s63, s63, s64
    s_cselect_b32 s65, 1, 2
    s_cselect_b32 s66, 0x3eb8aa3b, 1.0
    s_mov_b32 s67, s66
    s_lshl_b32 s64, s65, 16
    s_lshl_b32 s65, s65, 10
    v_lshlrev_b32 v2, 4, v1
    v_bfe_u32 v9, v1, 4, 1
    v_lshlrev_b32 v9, 17, v9
    v_lshl_add_u32 v9, v3, 8, v9
    v_and_b32 v30, 15, v1
    v_lshl_add_u32 v9, v30, 4, v9
    s_lshl_b32 s59, s3, 2
    s_add_u32 s59, s59, 137296
    v_mov_b32 v31, s59
    v_mov_b32 v30, 1
    s_waitcnt lgkmcnt(0)
    s_mov_b32 s28, s26
    s_mov_b32 s29, s27
    s_mov_b32 s30, 0x600000
    s_mov_b32 s31, 0x20000
    s_add_u32 s36, s26, 0xf00000
    s_addc_u32 s37, s27, 0
    s_mov_b32 s38, 0xc0000
    s_mov_b32 s39, 0x20000
    s_cmp_eq_u32 s61, 2
    s_cbranch_scc1 P1_V
    s_barrier
    ds_read_b128 v[112:115], v10 offset:0
    ds_read_b64_tr_b16 v[120:121], v18 offset:0
    ds_read_b64_tr_b16 v[122:123], v18 offset:512
    ds_read_b128 v[116:119], v10 offset:4096
    ds_read_b64_tr_b16 v[124:125], v19 offset:0
    ds_read_b64_tr_b16 v[126:127], v19 offset:512
    ds_read_b128 v[128:131], v11 offset:0
    ds_read_b64_tr_b16 v[136:137], v18 offset:2048
    ds_read_b64_tr_b16 v[138:139], v18 offset:2560
    ds_read_b128 v[132:135], v11 offset:4096
    ds_read_b64_tr_b16 v[140:141], v19 offset:2048
    ds_read_b64_tr_b16 v[142:143], v19 offset:2560
    s_waitcnt lgkmcnt(6)
    v_mfma_f32_32x32x16_bf16 v[48:63], v[120:123], v[112:115], 0
    ds_read_b128 v[144:147], v12 offset:0
    ds_read_b64_tr_b16 v[152:153], v18 offset:4096
    v_mfma_f32_32x32x16_bf16 v[64:79], v[120:123], v[116:119], 0
    ds_read_b64_tr_b16 v[154:155], v18 offset:4608
    ds_read_b128 v[148:151], v12 offset:4096
    v_mfma_f32_32x32x16_bf16 v[80:95], v[124:127], v[112:115], 0
    ds_read_b64_tr_b16 v[156:157], v19 offset:4096
    ds_read_b64_tr_b16 v[158:159], v19 offset:4608
    v_mfma_f32_32x32x16_bf16 v[96:111], v[124:127], v[116:119], 0
    s_waitcnt lgkmcnt(6)
    v_mfma_f32_32x32x16_bf16 v[48:63], v[136:139], v[128:131], v[48:63]
    ds_read_b128 v[112:115], v13 offset:0
    ds_read_b64_tr_b16 v[120:121], v18 offset:6144
    v_mfma_f32_32x32x16_bf16 v[64:79], v[136:139], v[132:135], v[64:79]
    ds_read_b64_tr_b16 v[122:123], v18 offset:6656
    ds_read_b128 v[116:119], v13 offset:4096
    v_mfma_f32_32x32x16_bf16 v[80:95], v[140:143], v[128:131], v[80:95]
    ds_read_b64_tr_b16 v[124:125], v19 offset:6144
    ds_read_b64_tr_b16 v[126:127], v19 offset:6656
    v_mfma_f32_32x32x16_bf16 v[96:111], v[140:143], v[132:135], v[96:111]
    s_barrier
    s_waitcnt lgkmcnt(6)
    v_mfma_f32_32x32x16_bf16 v[48:63], v[152:155], v[144:147], v[48:63]
    ds_read_b128 v[128:131], v10 offset:32768
    ds_read_b64_tr_b16 v[136:137], v18 offset:32768
    v_mfma_f32_32x32x16_bf16 v[64:79], v[152:155], v[148:151], v[64:79]
    ds_read_b64_tr_b16 v[138:139], v18 offset:33280
    ds_read_b128 v[132:135], v10 offset:36864
    v_mfma_f32_32x32x16_bf16 v[80:95], v[156:159], v[144:147], v[80:95]
    ds_read_b64_tr_b16 v[140:141], v19 offset:32768
    ds_read_b64_tr_b16 v[142:143], v19 offset:33280
    v_mfma_f32_32x32x16_bf16 v[96:111], v[156:159], v[148:151], v[96:111]
    s_waitcnt lgkmcnt(6)
    v_mfma_f32_32x32x16_bf16 v[48:63], v[120:123], v[112:115], v[48:63]
    ds_read_b128 v[144:147], v11 offset:32768
    ds_read_b64_tr_b16 v[152:153], v18 offset:34816
    v_mfma_f32_32x32x16_bf16 v[64:79], v[120:123], v[116:119], v[64:79]
    ds_read_b64_tr_b16 v[154:155], v18 offset:35328
    ds_read_b128 v[148:151], v11 offset:36864
    v_mfma_f32_32x32x16_bf16 v[80:95], v[124:127], v[112:115], v[80:95]
    ds_read_b64_tr_b16 v[156:157], v19 offset:34816
    ds_read_b64_tr_b16 v[158:159], v19 offset:35328
    v_mfma_f32_32x32x16_bf16 v[96:111], v[124:127], v[116:119], v[96:111]
    s_waitcnt lgkmcnt(6)
    v_mfma_f32_32x32x16_bf16 v[48:63], v[136:139], v[128:131], v[48:63]
    ds_read_b128 v[112:115], v12 offset:32768
    ds_read_b64_tr_b16 v[120:121], v18 offset:36864
    v_mfma_f32_32x32x16_bf16 v[64:79], v[136:139], v[132:135], v[64:79]
    ds_read_b64_tr_b16 v[122:123], v18 offset:37376
    ds_read_b128 v[116:119], v12 offset:36864
    v_mfma_f32_32x32x16_bf16 v[80:95], v[140:143], v[128:131], v[80:95]
    ds_read_b64_tr_b16 v[124:125], v19 offset:36864
    ds_read_b64_tr_b16 v[126:127], v19 offset:37376
    v_mfma_f32_32x32x16_bf16 v[96:111], v[140:143], v[132:135], v[96:111]
    s_waitcnt lgkmcnt(6)
    v_mfma_f32_32x32x16_bf16 v[48:63], v[152:155], v[144:147], v[48:63]
    ds_read_b128 v[128:131], v13 offset:32768
    ds_read_b64_tr_b16 v[136:137], v18 offset:38912
    v_mfma_f32_32x32x16_bf16 v[64:79], v[152:155], v[148:151], v[64:79]
    ds_read_b64_tr_b16 v[138:139], v18 offset:39424
    ds_read_b128 v[132:135], v13 offset:36864
    v_mfma_f32_32x32x16_bf16 v[80:95], v[156:159], v[144:147], v[80:95]
    ds_read_b64_tr_b16 v[140:141], v19 offset:38912
    ds_read_b64_tr_b16 v[142:143], v19 offset:39424
    v_mfma_f32_32x32x16_bf16 v[96:111], v[156:159], v[148:151], v[96:111]
    s_barrier
    s_waitcnt lgkmcnt(6)
    v_mfma_f32_32x32x16_bf16 v[48:63], v[120:123], v[112:115], v[48:63]
    ds_read_b128 v[144:147], v14 offset:0
    ds_read_b64_tr_b16 v[152:153], v20 offset:0
    v_mfma_f32_32x32x16_bf16 v[64:79], v[120:123], v[116:119], v[64:79]
    ds_read_b64_tr_b16 v[154:155], v20 offset:512
    ds_read_b128 v[148:151], v14 offset:4096
    v_mfma_f32_32x32x16_bf16 v[80:95], v[124:127], v[112:115], v[80:95]
    ds_read_b64_tr_b16 v[156:157], v21 offset:0
    ds_read_b64_tr_b16 v[158:159], v21 offset:512
    v_mfma_f32_32x32x16_bf16 v[96:111], v[124:127], v[116:119], v[96:111]
    s_waitcnt lgkmcnt(6)
    v_mfma_f32_32x32x16_bf16 v[48:63], v[136:139], v[128:131], v[48:63]
    ds_read_b128 v[112:115], v15 offset:0
    ds_read_b64_tr_b16 v[120:121], v20 offset:2048
    v_mfma_f32_32x32x16_bf16 v[64:79], v[136:139], v[132:135], v[64:79]
    ds_read_b64_tr_b16 v[122:123], v20 offset:2560
    ds_read_b128 v[116:119], v15 offset:4096
    v_mfma_f32_32x32x16_bf16 v[80:95], v[140:143], v[128:131], v[80:95]
    ds_read_b64_tr_b16 v[124:125], v21 offset:2048
    ds_read_b64_tr_b16 v[126:127], v21 offset:2560
    v_mfma_f32_32x32x16_bf16 v[96:111], v[140:143], v[132:135], v[96:111]
    s_waitcnt lgkmcnt(6)
    v_mfma_f32_32x32x16_bf16 v[48:63], v[152:155], v[144:147], v[48:63]
    ds_read_b128 v[128:131], v16 offset:0
    ds_read_b64_tr_b16 v[136:137], v20 offset:4096
    v_mfma_f32_32x32x16_bf16 v[64:79], v[152:155], v[148:151], v[64:79]
    ds_read_b64_tr_b16 v[138:139], v20 offset:4608
    ds_read_b128 v[132:135], v16 offset:4096
    v_mfma_f32_32x32x16_bf16 v[80:95], v[156:159], v[144:147], v[80:95]
    ds_read_b64_tr_b16 v[140:141], v21 offset:4096
    ds_read_b64_tr_b16 v[142:143], v21 offset:4608
    v_mfma_f32_32x32x16_bf16 v[96:111], v[156:159], v[148:151], v[96:111]
    s_waitcnt lgkmcnt(6)
    v_mfma_f32_32x32x16_bf16 v[48:63], v[120:123], v[112:115], v[48:63]
    ds_read_b128 v[144:147], v17 offset:0
    ds_read_b64_tr_b16 v[152:153], v20 offset:6144
    v_mfma_f32_32x32x16_bf16 v[64:79], v[120:123], v[116:119], v[64:79]
    ds_read_b64_tr_b16 v[154:155], v20 offset:6656
    ds_read_b128 v[148:151], v17 offset:4096
    v_mfma_f32_32x32x16_bf16 v[80:95], v[124:127], v[112:115], v[80:95]
    ds_read_b64_tr_b16 v[156:157], v21 offset:6144
    ds_read_b64_tr_b16 v[158:159], v21 offset:6656
    v_mfma_f32_32x32x16_bf16 v[96:111], v[124:127], v[116:119], v[96:111]
    s_barrier
    s_waitcnt lgkmcnt(6)
    v_mfma_f32_32x32x16_bf16 v[48:63], v[136:139], v[128:131], v[48:63]
    ds_read_b128 v[112:115], v14 offset:32768
    ds_read_b64_tr_b16 v[120:121], v20 offset:32768
    v_mfma_f32_32x32x16_bf16 v[64:79], v[136:139], v[132:135], v[64:79]
    ds_read_b64_tr_b16 v[122:123], v20 offset:33280
    ds_read_b128 v[116:119], v14 offset:36864
    v_mfma_f32_32x32x16_bf16 v[80:95], v[140:143], v[128:131], v[80:95]
    ds_read_b64_tr_b16 v[124:125], v21 offset:32768
    ds_read_b64_tr_b16 v[126:127], v21 offset:33280
    v_mfma_f32_32x32x16_bf16 v[96:111], v[140:143], v[132:135], v[96:111]
    s_waitcnt lgkmcnt(6)
    v_mfma_f32_32x32x16_bf16 v[48:63], v[152:155], v[144:147], v[48:63]
    ds_read_b128 v[128:131], v15 offset:32768
    ds_read_b64_tr_b16 v[136:137], v20 offset:34816
    v_mfma_f32_32x32x16_bf16 v[64:79], v[152:155], v[148:151], v[64:79]
    ds_read_b64_tr_b16 v[138:139], v20 offset:35328
    ds_read_b128 v[132:135], v15 offset:36864
    v_mfma_f32_32x32x16_bf16 v[80:95], v[156:159], v[144:147], v[80:95]
    ds_read_b64_tr_b16 v[140:141], v21 offset:34816
    ds_read_b64_tr_b16 v[142:143], v21 offset:35328
    v_mfma_f32_32x32x16_bf16 v[96:111], v[156:159], v[148:151], v[96:111]
    s_waitcnt lgkmcnt(6)
    v_mfma_f32_32x32x16_bf16 v[48:63], v[120:123], v[112:115], v[48:63]
    ds_read_b128 v[144:147], v16 offset:32768
    ds_read_b64_tr_b16 v[152:153], v20 offset:36864
    v_mfma_f32_32x32x16_bf16 v[64:79], v[120:123], v[116:119], v[64:79]
    ds_read_b64_tr_b16 v[154:155], v20 offset:37376
    ds_read_b128 v[148:151], v16 offset:36864
    v_mfma_f32_32x32x16_bf16 v[80:95], v[124:127], v[112:115], v[80:95]
    ds_read_b64_tr_b16 v[156:157], v21 offset:36864
    ds_read_b64_tr_b16 v[158:159], v21 offset:37376
    v_mfma_f32_32x32x16_bf16 v[96:111], v[124:127], v[116:119], v[96:111]
    s_waitcnt lgkmcnt(6)
    v_mfma_f32_32x32x16_bf16 v[48:63], v[136:139], v[128:131], v[48:63]
    ds_read_b128 v[112:115], v17 offset:32768
    ds_read_b64_tr_b16 v[120:121], v20 offset:38912
    v_mfma_f32_32x32x16_bf16 v[64:79], v[136:139], v[132:135], v[64:79]
    ds_read_b64_tr_b16 v[122:123], v20 offset:39424
    ds_read_b128 v[116:119], v17 offset:36864
    v_mfma_f32_32x32x16_bf16 v[80:95], v[140:143], v[128:131], v[80:95]
    ds_read_b64_tr_b16 v[124:125], v21 offset:38912
    ds_read_b64_tr_b16 v[126:127], v21 offset:39424
    v_mfma_f32_32x32x16_bf16 v[96:111], v[140:143], v[132:135], v[96:111]
    s_barrier
    s_waitcnt lgkmcnt(6)
    v_mfma_f32_32x32x16_bf16 v[48:63], v[152:155], v[144:147], v[48:63]
    ds_read_b128 v[128:131], v10 offset:0
    ds_read_b64_tr_b16 v[136:137], v18 offset:0
    v_mfma_f32_32x32x16_bf16 v[64:79], v[152:155], v[148:151], v[64:79]
    ds_read_b64_tr_b16 v[138:139], v18 offset:512
    ds_read_b128 v[132:135], v10 offset:4096
    v_mfma_f32_32x32x16_bf16 v[80:95], v[156:159], v[144:147], v[80:95]
    ds_read_b64_tr_b16 v[140:141], v19 offset:0
    ds_read_b64_tr_b16 v[142:143], v19 offset:512
    v_mfma_f32_32x32x16_bf16 v[96:111], v[156:159], v[148:151], v[96:111]
    s_waitcnt lgkmcnt(6)
    v_mfma_f32_32x32x16_bf16 v[48:63], v[120:123], v[112:115], v[48:63]
    ds_read_b128 v[144:147], v11 offset:0
    ds_read_b64_tr_b16 v[152:153], v18 offset:2048
    v_mfma_f32_32x32x16_bf16 v[64:79], v[120:123], v[116:119], v[64:79]
    ds_read_b64_tr_b16 v[154:155], v18 offset:2560
    ds_read_b128 v[148:151], v11 offset:4096
    v_mfma_f32_32x32x16_bf16 v[80:95], v[124:127], v[112:115], v[80:95]
    ds_read_b64_tr_b16 v[156:157], v19 offset:2048
    ds_read_b64_tr_b16 v[158:159], v19 offset:2560
    v_mfma_f32_32x32x16_bf16 v[96:111], v[124:127], v[116:119], v[96:111]
    s_waitcnt lgkmcnt(6)
    v_mfma_f32_32x32x16_bf16 v[48:63], v[136:139], v[128:131], v[48:63]
    ds_read_b128 v[112:115], v12 offset:0
    ds_read_b64_tr_b16 v[120:121], v18 offset:4096
    v_mfma_f32_32x32x16_bf16 v[64:79], v[136:139], v[132:135], v[64:79]
    ds_read_b64_tr_b16 v[122:123], v18 offset:4608
    ds_read_b128 v[116:119], v12 offset:4096
    v_mfma_f32_32x32x16_bf16 v[80:95], v[140:143], v[128:131], v[80:95]
    ds_read_b64_tr_b16 v[124:125], v19 offset:4096
    ds_read_b64_tr_b16 v[126:127], v19 offset:4608
    v_mfma_f32_32x32x16_bf16 v[96:111], v[140:143], v[132:135], v[96:111]
    s_waitcnt lgkmcnt(6)
    v_mfma_f32_32x32x16_bf16 v[48:63], v[152:155], v[144:147], v[48:63]
    ds_read_b128 v[128:131], v13 offset:0
    ds_read_b64_tr_b16 v[136:137], v18 offset:6144
    v_mfma_f32_32x32x16_bf16 v[64:79], v[152:155], v[148:151], v[64:79]
    ds_read_b64_tr_b16 v[138:139], v18 offset:6656
    ds_read_b128 v[132:135], v13 offset:4096
    v_mfma_f32_32x32x16_bf16 v[80:95], v[156:159], v[144:147], v[80:95]
    ds_read_b64_tr_b16 v[140:141], v19 offset:6144
    ds_read_b64_tr_b16 v[142:143], v19 offset:6656
    v_mfma_f32_32x32x16_bf16 v[96:111], v[156:159], v[148:151], v[96:111]
    s_barrier
    s_waitcnt lgkmcnt(6)
    v_mfma_f32_32x32x16_bf16 v[48:63], v[120:123], v[112:115], v[48:63]
    ds_read_b128 v[144:147], v10 offset:32768
    ds_read_b64_tr_b16 v[152:153], v18 offset:32768
    v_mfma_f32_32x32x16_bf16 v[64:79], v[120:123], v[116:119], v[64:79]
    ds_read_b64_tr_b16 v[154:155], v18 offset:33280
    ds_read_b128 v[148:151], v10 offset:36864
    v_mfma_f32_32x32x16_bf16 v[80:95], v[124:127], v[112:115], v[80:95]
    ds_read_b64_tr_b16 v[156:157], v19 offset:32768
    ds_read_b64_tr_b16 v[158:159], v19 offset:33280
    v_mfma_f32_32x32x16_bf16 v[96:111], v[124:127], v[116:119], v[96:111]
    s_waitcnt lgkmcnt(6)
    v_mfma_f32_32x32x16_bf16 v[48:63], v[136:139], v[128:131], v[48:63]
    ds_read_b128 v[112:115], v11 offset:32768
    ds_read_b64_tr_b16 v[120:121], v18 offset:34816
    v_mfma_f32_32x32x16_bf16 v[64:79], v[136:139], v[132:135], v[64:79]
    ds_read_b64_tr_b16 v[122:123], v18 offset:35328
    ds_read_b128 v[116:119], v11 offset:36864
    v_mfma_f32_32x32x16_bf16 v[80:95], v[140:143], v[128:131], v[80:95]
    ds_read_b64_tr_b16 v[124:125], v19 offset:34816
    ds_read_b64_tr_b16 v[126:127], v19 offset:35328
    v_mfma_f32_32x32x16_bf16 v[96:111], v[140:143], v[132:135], v[96:111]
    s_waitcnt lgkmcnt(6)
    v_mfma_f32_32x32x16_bf16 v[48:63], v[152:155], v[144:147], v[48:63]
    ds_read_b128 v[128:131], v12 offset:32768
    ds_read_b64_tr_b16 v[136:137], v18 offset:36864
    v_mfma_f32_32x32x16_bf16 v[64:79], v[152:155], v[148:151], v[64:79]
    ds_read_b64_tr_b16 v[138:139], v18 offset:37376
    ds_read_b128 v[132:135], v12 offset:36864
    v_mfma_f32_32x32x16_bf16 v[80:95], v[156:159], v[144:147], v[80:95]
    ds_read_b64_tr_b16 v[140:141], v19 offset:36864
    ds_read_b64_tr_b16 v[142:143], v19 offset:37376
    v_mfma_f32_32x32x16_bf16 v[96:111], v[156:159], v[148:151], v[96:111]
    s_waitcnt lgkmcnt(6)
    v_mfma_f32_32x32x16_bf16 v[48:63], v[120:123], v[112:115], v[48:63]
    ds_read_b128 v[144:147], v13 offset:32768
    ds_read_b64_tr_b16 v[152:153], v18 offset:38912
    v_mfma_f32_32x32x16_bf16 v[64:79], v[120:123], v[116:119], v[64:79]
    ds_read_b64_tr_b16 v[154:155], v18 offset:39424
    ds_read_b128 v[148:151], v13 offset:36864
    v_mfma_f32_32x32x16_bf16 v[80:95], v[124:127], v[112:115], v[80:95]
    ds_read_b64_tr_b16 v[156:157], v19 offset:38912
    ds_read_b64_tr_b16 v[158:159], v19 offset:39424
    v_mfma_f32_32x32x16_bf16 v[96:111], v[124:127], v[116:119], v[96:111]
    s_barrier
    s_waitcnt lgkmcnt(6)
    v_mfma_f32_32x32x16_bf16 v[48:63], v[136:139], v[128:131], v[48:63]
    ds_read_b128 v[112:115], v14 offset:0
    ds_read_b64_tr_b16 v[120:121], v20 offset:0
    v_mfma_f32_32x32x16_bf16 v[64:79], v[136:139], v[132:135], v[64:79]
    ds_read_b64_tr_b16 v[122:123], v20 offset:512
    ds_read_b128 v[116:119], v14 offset:4096
    v_mfma_f32_32x32x16_bf16 v[80:95], v[140:143], v[128:131], v[80:95]
    ds_read_b64_tr_b16 v[124:125], v21 offset:0
    ds_read_b64_tr_b16 v[126:127], v21 offset:512
    v_mfma_f32_32x32x16_bf16 v[96:111], v[140:143], v[132:135], v[96:111]
    s_waitcnt lgkmcnt(6)
    v_mfma_f32_32x32x16_bf16 v[48:63], v[152:155], v[144:147], v[48:63]
    ds_read_b128 v[128:131], v15 offset:0
    ds_read_b64_tr_b16 v[136:137], v20 offset:2048
    v_mfma_f32_32x32x16_bf16 v[64:79], v[152:155], v[148:151], v[64:79]
    ds_read_b64_tr_b16 v[138:139], v20 offset:2560
    ds_read_b128 v[132:135], v15 offset:4096
    v_mfma_f32_32x32x16_bf16 v[80:95], v[156:159], v[144:147], v[80:95]
    ds_read_b64_tr_b16 v[140:141], v21 offset:2048
    ds_read_b64_tr_b16 v[142:143], v21 offset:2560
    v_mfma_f32_32x32x16_bf16 v[96:111], v[156:159], v[148:151], v[96:111]
    s_waitcnt lgkmcnt(6)
    v_mfma_f32_32x32x16_bf16 v[48:63], v[120:123], v[112:115], v[48:63]
    ds_read_b128 v[144:147], v16 offset:0
    ds_read_b64_tr_b16 v[152:153], v20 offset:4096
    v_mfma_f32_32x32x16_bf16 v[64:79], v[120:123], v[116:119], v[64:79]
    ds_read_b64_tr_b16 v[154:155], v20 offset:4608
    ds_read_b128 v[148:151], v16 offset:4096
    v_mfma_f32_32x32x16_bf16 v[80:95], v[124:127], v[112:115], v[80:95]
    ds_read_b64_tr_b16 v[156:157], v21 offset:4096
    ds_read_b64_tr_b16 v[158:159], v21 offset:4608
    v_mfma_f32_32x32x16_bf16 v[96:111], v[124:127], v[116:119], v[96:111]
    s_waitcnt lgkmcnt(6)
    v_mfma_f32_32x32x16_bf16 v[48:63], v[136:139], v[128:131], v[48:63]
    ds_read_b128 v[112:115], v17 offset:0
    ds_read_b64_tr_b16 v[120:121], v20 offset:6144
    v_mfma_f32_32x32x16_bf16 v[64:79], v[136:139], v[132:135], v[64:79]
    ds_read_b64_tr_b16 v[122:123], v20 offset:6656
    ds_read_b128 v[116:119], v17 offset:4096
    v_mfma_f32_32x32x16_bf16 v[80:95], v[140:143], v[128:131], v[80:95]
    ds_read_b64_tr_b16 v[124:125], v21 offset:6144
    ds_read_b64_tr_b16 v[126:127], v21 offset:6656
    v_mfma_f32_32x32x16_bf16 v[96:111], v[140:143], v[132:135], v[96:111]
    s_barrier
    s_waitcnt lgkmcnt(6)
    v_mfma_f32_32x32x16_bf16 v[48:63], v[152:155], v[144:147], v[48:63]
    ds_read_b128 v[128:131], v14 offset:32768
    ds_read_b64_tr_b16 v[136:137], v20 offset:32768
    v_mfma_f32_32x32x16_bf16 v[64:79], v[152:155], v[148:151], v[64:79]
    ds_read_b64_tr_b16 v[138:139], v20 offset:33280
    ds_read_b128 v[132:135], v14 offset:36864
    v_mfma_f32_32x32x16_bf16 v[80:95], v[156:159], v[144:147], v[80:95]
    ds_read_b64_tr_b16 v[140:141], v21 offset:32768
    ds_read_b64_tr_b16 v[142:143], v21 offset:33280
    v_mfma_f32_32x32x16_bf16 v[96:111], v[156:159], v[148:151], v[96:111]
    s_waitcnt lgkmcnt(6)
    v_mfma_f32_32x32x16_bf16 v[48:63], v[120:123], v[112:115], v[48:63]
    ds_read_b128 v[144:147], v15 offset:32768
    ds_read_b64_tr_b16 v[152:153], v20 offset:34816
    v_mfma_f32_32x32x16_bf16 v[64:79], v[120:123], v[116:119], v[64:79]
    ds_read_b64_tr_b16 v[154:155], v20 offset:35328
    ds_read_b128 v[148:151], v15 offset:36864
    v_mfma_f32_32x32x16_bf16 v[80:95], v[124:127], v[112:115], v[80:95]
    ds_read_b64_tr_b16 v[156:157], v21 offset:34816
    ds_read_b64_tr_b16 v[158:159], v21 offset:35328
    v_mfma_f32_32x32x16_bf16 v[96:111], v[124:127], v[116:119], v[96:111]
    s_waitcnt lgkmcnt(6)
    v_mfma_f32_32x32x16_bf16 v[48:63], v[136:139], v[128:131], v[48:63]
    ds_read_b128 v[112:115], v16 offset:32768
    ds_read_b64_tr_b16 v[120:121], v20 offset:36864
    v_mfma_f32_32x32x16_bf16 v[64:79], v[136:139], v[132:135], v[64:79]
    ds_read_b64_tr_b16 v[122:123], v20 offset:37376
    ds_read_b128 v[116:119], v16 offset:36864
    v_mfma_f32_32x32x16_bf16 v[80:95], v[140:143], v[128:131], v[80:95]
    ds_read_b64_tr_b16 v[124:125], v21 offset:36864
    ds_read_b64_tr_b16 v[126:127], v21 offset:37376
    v_mfma_f32_32x32x16_bf16 v[96:111], v[140:143], v[132:135], v[96:111]
    s_waitcnt lgkmcnt(6)
    v_mfma_f32_32x32x16_bf16 v[48:63], v[152:155], v[144:147], v[48:63]
    ds_read_b128 v[128:131], v17 offset:32768
    ds_read_b64_tr_b16 v[136:137], v20 offset:38912
    v_mfma_f32_32x32x16_bf16 v[64:79], v[152:155], v[148:151], v[64:79]
    ds_read_b64_tr_b16 v[138:139], v20 offset:39424
    ds_read_b128 v[132:135], v17 offset:36864
    v_mfma_f32_32x32x16_bf16 v[80:95], v[156:159], v[144:147], v[80:95]
    ds_read_b64_tr_b16 v[140:141], v21 offset:38912
    ds_read_b64_tr_b16 v[142:143], v21 offset:39424
    v_mfma_f32_32x32x16_bf16 v[96:111], v[156:159], v[148:151], v[96:111]
    s_waitcnt lgkmcnt(6)
    v_mfma_f32_32x32x16_bf16 v[48:63], v[120:123], v[112:115], v[48:63]
    v_mfma_f32_32x32x16_bf16 v[64:79], v[120:123], v[116:119], v[64:79]
    v_mfma_f32_32x32x16_bf16 v[80:95], v[124:127], v[112:115], v[80:95]
    v_mfma_f32_32x32x16_bf16 v[96:111], v[124:127], v[116:119], v[96:111]
    s_waitcnt lgkmcnt(0)
    v_mfma_f32_32x32x16_bf16 v[48:63], v[136:139], v[128:131], v[48:63]
    v_mfma_f32_32x32x16_bf16 v[64:79], v[136:139], v[132:135], v[64:79]
    v_mfma_f32_32x32x16_bf16 v[80:95], v[140:143], v[128:131], v[80:95]
    v_mfma_f32_32x32x16_bf16 v[96:111], v[140:143], v[132:135], v[96:111]
    v_mov_b32 v32, 137472
    ds_read_b64 v[166:167], v32
    s_mov_b32 s59, s63
    s_add_u32 s60, s59, s64
    s_nop 4
    v_pk_mul_f32 v[48:49], v[48:49], s[66:67]
    v_pk_mul_f32 v[50:51], v[50:51], s[66:67]
    v_pk_mul_f32 v[52:53], v[52:53], s[66:67]
    v_pk_mul_f32 v[54:55], v[54:55], s[66:67]
    v_cvt_pk_bf16_f32 v112, v48, v49
    v_cvt_pk_bf16_f32 v113, v50, v51
    v_cvt_pk_bf16_f32 v114, v52, v53
    v_cvt_pk_bf16_f32 v115, v54, v55
    buffer_store_dwordx4 v[112:115], v2, s[28:31], s59 offen sc1
    v_pk_mul_f32 v[56:57], v[56:57], s[66:67]
    v_pk_mul_f32 v[58:59], v[58:59], s[66:67]
    v_pk_mul_f32 v[60:61], v[60:61], s[66:67]
    v_pk_mul_f32 v[62:63], v[62:63], s[66:67]
    v_cvt_pk_bf16_f32 v116, v56, v57
    v_cvt_pk_bf16_f32 v117, v58, v59
    v_cvt_pk_bf16_f32 v118, v60, v61
    v_cvt_pk_bf16_f32 v119, v62, v63
    buffer_store_dwordx4 v[116:119], v2, s[28:31], s60 offen sc1
    s_add_u32 s59, s63, s65
    s_add_u32 s60, s59, s64
    v_pk_mul_f32 v[64:65], v[64:65], s[66:67]
    v_pk_mul_f32 v[66:67], v[66:67], s[66:67]
    v_pk_mul_f32 v[68:69], v[68:69], s[66:67]
    v_pk_mul_f32 v[70:71], v[70:71], s[66:67]
    v_cvt_pk_bf16_f32 v120, v64, v65
    v_cvt_pk_bf16_f32 v121, v66, v67
    v_cvt_pk_bf16_f32 v122, v68, v69
    v_cvt_pk_bf16_f32 v123, v70, v71
    buffer_store_dwordx4 v[120:123], v2, s[28:31], s59 offen sc1
    v_pk_mul_f32 v[72:73], v[72:73], s[66:67]
    v_pk_mul_f32 v[74:75], v[74:75], s[66:67]
    v_pk_mul_f32 v[76:77], v[76:77], s[66:67]
    v_pk_mul_f32 v[78:79], v[78:79], s[66:67]
    v_cvt_pk_bf16_f32 v124, v72, v73
    v_cvt_pk_bf16_f32 v125, v74, v75
    v_cvt_pk_bf16_f32 v126, v76, v77
    v_cvt_pk_bf16_f32 v127, v78, v79
    buffer_store_dwordx4 v[124:127], v2, s[28:31], s60 offen sc1
    s_lshl_b32 s60, s64, 1
    s_add_u32 s63, s63, s60
    s_mov_b32 s59, s63
    s_add_u32 s60, s59, s64
    v_pk_mul_f32 v[80:81], v[80:81], s[66:67]
    v_pk_mul_f32 v[82:83], v[82:83], s[66:67]
    v_pk_mul_f32 v[84:85], v[84:85], s[66:67]
    v_pk_mul_f32 v[86:87], v[86:87], s[66:67]
    v_cvt_pk_bf16_f32 v128, v80, v81
    v_cvt_pk_bf16_f32 v129, v82, v83
    v_cvt_pk_bf16_f32 v130, v84, v85
    v_cvt_pk_bf16_f32 v131, v86, v87
    buffer_store_dwordx4 v[128:131], v2, s[28:31], s59 offen sc1
    v_pk_mul_f32 v[88:89], v[88:89], s[66:67]
    v_pk_mul_f32 v[90:91], v[90:91], s[66:67]
    v_pk_mul_f32 v[92:93], v[92:93], s[66:67]
    v_pk_mul_f32 v[94:95], v[94:95], s[66:67]
    v_cvt_pk_bf16_f32 v132, v88, v89
    v_cvt_pk_bf16_f32 v133, v90, v91
    v_cvt_pk_bf16_f32 v134, v92, v93
    v_cvt_pk_bf16_f32 v135, v94, v95
    buffer_store_dwordx4 v[132:135], v2, s[28:31], s60 offen sc1
    s_add_u32 s59, s63, s65
    s_add_u32 s60, s59, s64
    v_pk_mul_f32 v[96:97], v[96:97], s[66:67]
    v_pk_mul_f32 v[98:99], v[98:99], s[66:67]
    v_pk_mul_f32 v[100:101], v[100:101], s[66:67]
    v_pk_mul_f32 v[102:103], v[102:103], s[66:67]
    v_cvt_pk_bf16_f32 v136, v96, v97
    v_cvt_pk_bf16_f32 v137, v98, v99
    v_cvt_pk_bf16_f32 v138, v100, v101
    v_cvt_pk_bf16_f32 v139, v102, v103
    buffer_store_dwordx4 v[136:139], v2, s[28:31], s59 offen sc1
    v_pk_mul_f32 v[104:105], v[104:105], s[66:67]
    v_pk_mul_f32 v[106:107], v[106:107], s[66:67]
    v_pk_mul_f32 v[108:109], v[108:109], s[66:67]
    v_pk_mul_f32 v[110:111], v[110:111], s[66:67]
    v_cvt_pk_bf16_f32 v140, v104, v105
    v_cvt_pk_bf16_f32 v141, v106, v107
    v_cvt_pk_bf16_f32 v142, v108, v109
    v_cvt_pk_bf16_f32 v143, v110, v111
    buffer_store_dwordx4 v[140:143], v2, s[28:31], s60 offen sc1
    s_branch P1_PUB
P1_V:
    s_barrier
    ds_read_b128 v[112:115], v10 offset:0
    ds_read_b64_tr_b16 v[120:121], v18 offset:0
    ds_read_b64_tr_b16 v[122:123], v18 offset:512
    ds_read_b128 v[116:119], v10 offset:4096
    ds_read_b64_tr_b16 v[124:125], v19 offset:0
    ds_read_b64_tr_b16 v[126:127], v19 offset:512
    ds_read_b128 v[128:131], v11 offset:0
    ds_read_b64_tr_b16 v[136:137], v18 offset:2048
    ds_read_b64_tr_b16 v[138:139], v18 offset:2560
    ds_read_b128 v[132:135], v11 offset:4096
    ds_read_b64_tr_b16 v[140:141], v19 offset:2048
    ds_read_b64_tr_b16 v[142:143], v19 offset:2560
    s_waitcnt lgkmcnt(6)
    v_mfma_f32_32x32x16_bf16 v[48:63], v[112:115], v[120:123], 0
    ds_read_b128 v[144:147], v12 offset:0
    ds_read_b64_tr_b16 v[152:153], v18 offset:4096
    v_mfma_f32_32x32x16_bf16 v[64:79], v[116:119], v[120:123], 0
    ds_read_b64_tr_b16 v[154:155], v18 offset:4608
    ds_read_b128 v[148:151], v12 offset:4096
    v_mfma_f32_32x32x16_bf16 v[80:95], v[112:115], v[124:127], 0
    ds_read_b64_tr_b16 v[156:157], v19 offset:4096
    ds_read_b64_tr_b16 v[158:159], v19 offset:4608
    v_mfma_f32_32x32x16_bf16 v[96:111], v[116:119], v[124:127], 0
    s_waitcnt lgkmcnt(6)
    v_mfma_f32_32x32x16_bf16 v[48:63], v[128:131], v[136:139], v[48:63]
    ds_read_b128 v[112:115], v13 offset:0
    ds_read_b64_tr_b16 v[120:121], v18 offset:6144
    v_mfma_f32_32x32x16_bf16 v[64:79], v[132:135], v[136:139], v[64:79]
    ds_read_b64_tr_b16 v[122:123], v18 offset:6656
    ds_read_b128 v[116:119], v13 offset:4096
    v_mfma_f32_32x32x16_bf16 v[80:95], v[128:131], v[140:143], v[80:95]
    ds_read_b64_tr_b16 v[124:125], v19 offset:6144
    ds_read_b64_tr_b16 v[126:127], v19 offset:6656
    v_mfma_f32_32x32x16_bf16 v[96:111], v[132:135], v[140:143], v[96:111]
    s_barrier
    s_waitcnt lgkmcnt(6)
    v_mfma_f32_32x32x16_bf16 v[48:63], v[144:147], v[152:155], v[48:63]
    ds_read_b128 v[128:131], v10 offset:32768
    ds_read_b64_tr_b16 v[136:137], v18 offset:32768
    v_mfma_f32_32x32x16_bf16 v[64:79], v[148:151], v[152:155], v[64:79]
    ds_read_b64_tr_b16 v[138:139], v18 offset:33280
    ds_read_b128 v[132:135], v10 offset:36864
    v_mfma_f32_32x32x16_bf16 v[80:95], v[144:147], v[156:159], v[80:95]
    ds_read_b64_tr_b16 v[140:141], v19 offset:32768
    ds_read_b64_tr_b16 v[142:143], v19 offset:33280
    v_mfma_f32_32x32x16_bf16 v[96:111], v[148:151], v[156:159], v[96:111]
    s_waitcnt lgkmcnt(6)
    v_mfma_f32_32x32x16_bf16 v[48:63], v[112:115], v[120:123], v[48:63]
    ds_read_b128 v[144:147], v11 offset:32768
    ds_read_b64_tr_b16 v[152:153], v18 offset:34816
    v_mfma_f32_32x32x16_bf16 v[64:79], v[116:119], v[120:123], v[64:79]
    ds_read_b64_tr_b16 v[154:155], v18 offset:35328
    ds_read_b128 v[148:151], v11 offset:36864
    v_mfma_f32_32x32x16_bf16 v[80:95], v[112:115], v[124:127], v[80:95]
    ds_read_b64_tr_b16 v[156:157], v19 offset:34816
    ds_read_b64_tr_b16 v[158:159], v19 offset:35328
    v_mfma_f32_32x32x16_bf16 v[96:111], v[116:119], v[124:127], v[96:111]
    s_waitcnt lgkmcnt(6)
    v_mfma_f32_32x32x16_bf16 v[48:63], v[128:131], v[136:139], v[48:63]
    ds_read_b128 v[112:115], v12 offset:32768
    ds_read_b64_tr_b16 v[120:121], v18 offset:36864
    v_mfma_f32_32x32x16_bf16 v[64:79], v[132:135], v[136:139], v[64:79]
    ds_read_b64_tr_b16 v[122:123], v18 offset:37376
    ds_read_b128 v[116:119], v12 offset:36864
    v_mfma_f32_32x32x16_bf16 v[80:95], v[128:131], v[140:143], v[80:95]
    ds_read_b64_tr_b16 v[124:125], v19 offset:36864
    ds_read_b64_tr_b16 v[126:127], v19 offset:37376
    v_mfma_f32_32x32x16_bf16 v[96:111], v[132:135], v[140:143], v[96:111]
    s_waitcnt lgkmcnt(6)
    v_mfma_f32_32x32x16_bf16 v[48:63], v[144:147], v[152:155], v[48:63]
    ds_read_b128 v[128:131], v13 offset:32768
    ds_read_b64_tr_b16 v[136:137], v18 offset:38912
    v_mfma_f32_32x32x16_bf16 v[64:79], v[148:151], v[152:155], v[64:79]
    ds_read_b64_tr_b16 v[138:139], v18 offset:39424
    ds_read_b128 v[132:135], v13 offset:36864
    v_mfma_f32_32x32x16_bf16 v[80:95], v[144:147], v[156:159], v[80:95]
    ds_read_b64_tr_b16 v[140:141], v19 offset:38912
    ds_read_b64_tr_b16 v[142:143], v19 offset:39424
    v_mfma_f32_32x32x16_bf16 v[96:111], v[148:151], v[156:159], v[96:111]
    s_barrier
    s_waitcnt lgkmcnt(6)
    v_mfma_f32_32x32x16_bf16 v[48:63], v[112:115], v[120:123], v[48:63]
    ds_read_b128 v[144:147], v14 offset:0
    ds_read_b64_tr_b16 v[152:153], v20 offset:0
    v_mfma_f32_32x32x16_bf16 v[64:79], v[116:119], v[120:123], v[64:79]
    ds_read_b64_tr_b16 v[154:155], v20 offset:512
    ds_read_b128 v[148:151], v14 offset:4096
    v_mfma_f32_32x32x16_bf16 v[80:95], v[112:115], v[124:127], v[80:95]
    ds_read_b64_tr_b16 v[156:157], v21 offset:0
    ds_read_b64_tr_b16 v[158:159], v21 offset:512
    v_mfma_f32_32x32x16_bf16 v[96:111], v[116:119], v[124:127], v[96:111]
    s_waitcnt lgkmcnt(6)
    v_mfma_f32_32x32x16_bf16 v[48:63], v[128:131], v[136:139], v[48:63]
    ds_read_b128 v[112:115], v15 offset:0
    ds_read_b64_tr_b16 v[120:121], v20 offset:2048
    v_mfma_f32_32x32x16_bf16 v[64:79], v[132:135], v[136:139], v[64:79]
    ds_read_b64_tr_b16 v[122:123], v20 offset:2560
    ds_read_b128 v[116:119], v15 offset:4096
    v_mfma_f32_32x32x16_bf16 v[80:95], v[128:131], v[140:143], v[80:95]
    ds_read_b64_tr_b16 v[124:125], v21 offset:2048
    ds_read_b64_tr_b16 v[126:127], v21 offset:2560
    v_mfma_f32_32x32x16_bf16 v[96:111], v[132:135], v[140:143], v[96:111]
    s_waitcnt lgkmcnt(6)
    v_mfma_f32_32x32x16_bf16 v[48:63], v[144:147], v[152:155], v[48:63]
    ds_read_b128 v[128:131], v16 offset:0
    ds_read_b64_tr_b16 v[136:137], v20 offset:4096
    v_mfma_f32_32x32x16_bf16 v[64:79], v[148:151], v[152:155], v[64:79]
    ds_read_b64_tr_b16 v[138:139], v20 offset:4608
    ds_read_b128 v[132:135], v16 offset:4096
    v_mfma_f32_32x32x16_bf16 v[80:95], v[144:147], v[156:159], v[80:95]
    ds_read_b64_tr_b16 v[140:141], v21 offset:4096
    ds_read_b64_tr_b16 v[142:143], v21 offset:4608
    v_mfma_f32_32x32x16_bf16 v[96:111], v[148:151], v[156:159], v[96:111]
    s_waitcnt lgkmcnt(6)
    v_mfma_f32_32x32x16_bf16 v[48:63], v[112:115], v[120:123], v[48:63]
    ds_read_b128 v[144:147], v17 offset:0
    ds_read_b64_tr_b16 v[152:153], v20 offset:6144
    v_mfma_f32_32x32x16_bf16 v[64:79], v[116:119], v[120:123], v[64:79]
    ds_read_b64_tr_b16 v[154:155], v20 offset:6656
    ds_read_b128 v[148:151], v17 offset:4096
    v_mfma_f32_32x32x16_bf16 v[80:95], v[112:115], v[124:127], v[80:95]
    ds_read_b64_tr_b16 v[156:157], v21 offset:6144
    ds_read_b64_tr_b16 v[158:159], v21 offset:6656
    v_mfma_f32_32x32x16_bf16 v[96:111], v[116:119], v[124:127], v[96:111]
    s_barrier
    s_waitcnt lgkmcnt(6)
    v_mfma_f32_32x32x16_bf16 v[48:63], v[128:131], v[136:139], v[48:63]
    ds_read_b128 v[112:115], v14 offset:32768
    ds_read_b64_tr_b16 v[120:121], v20 offset:32768
    v_mfma_f32_32x32x16_bf16 v[64:79], v[132:135], v[136:139], v[64:79]
    ds_read_b64_tr_b16 v[122:123], v20 offset:33280
    ds_read_b128 v[116:119], v14 offset:36864
    v_mfma_f32_32x32x16_bf16 v[80:95], v[128:131], v[140:143], v[80:95]
    ds_read_b64_tr_b16 v[124:125], v21 offset:32768
    ds_read_b64_tr_b16 v[126:127], v21 offset:33280
    v_mfma_f32_32x32x16_bf16 v[96:111], v[132:135], v[140:143], v[96:111]
    s_waitcnt lgkmcnt(6)
    v_mfma_f32_32x32x16_bf16 v[48:63], v[144:147], v[152:155], v[48:63]
    ds_read_b128 v[128:131], v15 offset:32768
    ds_read_b64_tr_b16 v[136:137], v20 offset:34816
    v_mfma_f32_32x32x16_bf16 v[64:79], v[148:151], v[152:155], v[64:79]
    ds_read_b64_tr_b16 v[138:139], v20 offset:35328
    ds_read_b128 v[132:135], v15 offset:36864
    v_mfma_f32_32x32x16_bf16 v[80:95], v[144:147], v[156:159], v[80:95]
    ds_read_b64_tr_b16 v[140:141], v21 offset:34816
    ds_read_b64_tr_b16 v[142:143], v21 offset:35328
    v_mfma_f32_32x32x16_bf16 v[96:111], v[148:151], v[156:159], v[96:111]
    s_waitcnt lgkmcnt(6)
    v_mfma_f32_32x32x16_bf16 v[48:63], v[112:115], v[120:123], v[48:63]
    ds_read_b128 v[144:147], v16 offset:32768
    ds_read_b64_tr_b16 v[152:153], v20 offset:36864
    v_mfma_f32_32x32x16_bf16 v[64:79], v[116:119], v[120:123], v[64:79]
    ds_read_b64_tr_b16 v[154:155], v20 offset:37376
    ds_read_b128 v[148:151], v16 offset:36864
    v_mfma_f32_32x32x16_bf16 v[80:95], v[112:115], v[124:127], v[80:95]
    ds_read_b64_tr_b16 v[156:157], v21 offset:36864
    ds_read_b64_tr_b16 v[158:159], v21 offset:37376
    v_mfma_f32_32x32x16_bf16 v[96:111], v[116:119], v[124:127], v[96:111]
    s_waitcnt lgkmcnt(6)
    v_mfma_f32_32x32x16_bf16 v[48:63], v[128:131], v[136:139], v[48:63]
    ds_read_b128 v[112:115], v17 offset:32768
    ds_read_b64_tr_b16 v[120:121], v20 offset:38912
    v_mfma_f32_32x32x16_bf16 v[64:79], v[132:135], v[136:139], v[64:79]
    ds_read_b64_tr_b16 v[122:123], v20 offset:39424
    ds_read_b128 v[116:119], v17 offset:36864
    v_mfma_f32_32x32x16_bf16 v[80:95], v[128:131], v[140:143], v[80:95]
    ds_read_b64_tr_b16 v[124:125], v21 offset:38912
    ds_read_b64_tr_b16 v[126:127], v21 offset:39424
    v_mfma_f32_32x32x16_bf16 v[96:111], v[132:135], v[140:143], v[96:111]
    s_barrier
    s_waitcnt lgkmcnt(6)
    v_mfma_f32_32x32x16_bf16 v[48:63], v[144:147], v[152:155], v[48:63]
    ds_read_b128 v[128:131], v10 offset:0
    ds_read_b64_tr_b16 v[136:137], v18 offset:0
    v_mfma_f32_32x32x16_bf16 v[64:79], v[148:151], v[152:155], v[64:79]
    ds_read_b64_tr_b16 v[138:139], v18 offset:512
    ds_read_b128 v[132:135], v10 offset:4096
    v_mfma_f32_32x32x16_bf16 v[80:95], v[144:147], v[156:159], v[80:95]
    ds_read_b64_tr_b16 v[140:141], v19 offset:0
    ds_read_b64_tr_b16 v[142:143], v19 offset:512
    v_mfma_f32_32x32x16_bf16 v[96:111], v[148:151], v[156:159], v[96:111]
    s_waitcnt lgkmcnt(6)
    v_mfma_f32_32x32x16_bf16 v[48:63], v[112:115], v[120:123], v[48:63]
    ds_read_b128 v[144:147], v11 offset:0
    ds_read_b64_tr_b16 v[152:153], v18 offset:2048
    v_mfma_f32_32x32x16_bf16 v[64:79], v[116:119], v[120:123], v[64:79]
    ds_read_b64_tr_b16 v[154:155], v18 offset:2560
    ds_read_b128 v[148:151], v11 offset:4096
    v_mfma_f32_32x32x16_bf16 v[80:95], v[112:115], v[124:127], v[80:95]
    ds_read_b64_tr_b16 v[156:157], v19 offset:2048
    ds_read_b64_tr_b16 v[158:159], v19 offset:2560
    v_mfma_f32_32x32x16_bf16 v[96:111], v[116:119], v[124:127], v[96:111]
    s_waitcnt lgkmcnt(6)
    v_mfma_f32_32x32x16_bf16 v[48:63], v[128:131], v[136:139], v[48:63]
    ds_read_b128 v[112:115], v12 offset:0
    ds_read_b64_tr_b16 v[120:121], v18 offset:4096
    v_mfma_f32_32x32x16_bf16 v[64:79], v[132:135], v[136:139], v[64:79]
    ds_read_b64_tr_b16 v[122:123], v18 offset:4608
    ds_read_b128 v[116:119], v12 offset:4096
    v_mfma_f32_32x32x16_bf16 v[80:95], v[128:131], v[140:143], v[80:95]
    ds_read_b64_tr_b16 v[124:125], v19 offset:4096
    ds_read_b64_tr_b16 v[126:127], v19 offset:4608
    v_mfma_f32_32x32x16_bf16 v[96:111], v[132:135], v[140:143], v[96:111]
    s_waitcnt lgkmcnt(6)
    v_mfma_f32_32x32x16_bf16 v[48:63], v[144:147], v[152:155], v[48:63]
    ds_read_b128 v[128:131], v13 offset:0
    ds_read_b64_tr_b16 v[136:137], v18 offset:6144
    v_mfma_f32_32x32x16_bf16 v[64:79], v[148:151], v[152:155], v[64:79]
    ds_read_b64_tr_b16 v[138:139], v18 offset:6656
    ds_read_b128 v[132:135], v13 offset:4096
    v_mfma_f32_32x32x16_bf16 v[80:95], v[144:147], v[156:159], v[80:95]
    ds_read_b64_tr_b16 v[140:141], v19 offset:6144
    ds_read_b64_tr_b16 v[142:143], v19 offset:6656
    v_mfma_f32_32x32x16_bf16 v[96:111], v[148:151], v[156:159], v[96:111]
    s_barrier
    s_waitcnt lgkmcnt(6)
    v_mfma_f32_32x32x16_bf16 v[48:63], v[112:115], v[120:123], v[48:63]
    ds_read_b128 v[144:147], v10 offset:32768
    ds_read_b64_tr_b16 v[152:153], v18 offset:32768
    v_mfma_f32_32x32x16_bf16 v[64:79], v[116:119], v[120:123], v[64:79]
    ds_read_b64_tr_b16 v[154:155], v18 offset:33280
    ds_read_b128 v[148:151], v10 offset:36864
    v_mfma_f32_32x32x16_bf16 v[80:95], v[112:115], v[124:127], v[80:95]
    ds_read_b64_tr_b16 v[156:157], v19 offset:32768
    ds_read_b64_tr_b16 v[158:159], v19 offset:33280
    v_mfma_f32_32x32x16_bf16 v[96:111], v[116:119], v[124:127], v[96:111]
    s_waitcnt lgkmcnt(6)
    v_mfma_f32_32x32x16_bf16 v[48:63], v[128:131], v[136:139], v[48:63]
    ds_read_b128 v[112:115], v11 offset:32768
    ds_read_b64_tr_b16 v[120:121], v18 offset:34816
    v_mfma_f32_32x32x16_bf16 v[64:79], v[132:135], v[136:139], v[64:79]
    ds_read_b64_tr_b16 v[122:123], v18 offset:35328
    ds_read_b128 v[116:119], v11 offset:36864
    v_mfma_f32_32x32x16_bf16 v[80:95], v[128:131], v[140:143], v[80:95]
    ds_read_b64_tr_b16 v[124:125], v19 offset:34816
    ds_read_b64_tr_b16 v[126:127], v19 offset:35328
    v_mfma_f32_32x32x16_bf16 v[96:111], v[132:135], v[140:143], v[96:111]
    s_waitcnt lgkmcnt(6)
    v_mfma_f32_32x32x16_bf16 v[48:63], v[144:147], v[152:155], v[48:63]
    ds_read_b128 v[128:131], v12 offset:32768
    ds_read_b64_tr_b16 v[136:137], v18 offset:36864
    v_mfma_f32_32x32x16_bf16 v[64:79], v[148:151], v[152:155], v[64:79]
    ds_read_b64_tr_b16 v[138:139], v18 offset:37376
    ds_read_b128 v[132:135], v12 offset:36864
    v_mfma_f32_32x32x16_bf16 v[80:95], v[144:147], v[156:159], v[80:95]
    ds_read_b64_tr_b16 v[140:141], v19 offset:36864
    ds_read_b64_tr_b16 v[142:143], v19 offset:37376
    v_mfma_f32_32x32x16_bf16 v[96:111], v[148:151], v[156:159], v[96:111]
    s_waitcnt lgkmcnt(6)
    v_mfma_f32_32x32x16_bf16 v[48:63], v[112:115], v[120:123], v[48:63]
    ds_read_b128 v[144:147], v13 offset:32768
    ds_read_b64_tr_b16 v[152:153], v18 offset:38912
    v_mfma_f32_32x32x16_bf16 v[64:79], v[116:119], v[120:123], v[64:79]
    ds_read_b64_tr_b16 v[154:155], v18 offset:39424
    ds_read_b128 v[148:151], v13 offset:36864
    v_mfma_f32_32x32x16_bf16 v[80:95], v[112:115], v[124:127], v[80:95]
    ds_read_b64_tr_b16 v[156:157], v19 offset:38912
    ds_read_b64_tr_b16 v[158:159], v19 offset:39424
    v_mfma_f32_32x32x16_bf16 v[96:111], v[116:119], v[124:127], v[96:111]
    s_barrier
    s_waitcnt lgkmcnt(6)
    v_mfma_f32_32x32x16_bf16 v[48:63], v[128:131], v[136:139], v[48:63]
    ds_read_b128 v[112:115], v14 offset:0
    ds_read_b64_tr_b16 v[120:121], v20 offset:0
    v_mfma_f32_32x32x16_bf16 v[64:79], v[132:135], v[136:139], v[64:79]
    ds_read_b64_tr_b16 v[122:123], v20 offset:512
    ds_read_b128 v[116:119], v14 offset:4096
    v_mfma_f32_32x32x16_bf16 v[80:95], v[128:131], v[140:143], v[80:95]
    ds_read_b64_tr_b16 v[124:125], v21 offset:0
    ds_read_b64_tr_b16 v[126:127], v21 offset:512
    v_mfma_f32_32x32x16_bf16 v[96:111], v[132:135], v[140:143], v[96:111]
    s_waitcnt lgkmcnt(6)
    v_mfma_f32_32x32x16_bf16 v[48:63], v[144:147], v[152:155], v[48:63]
    ds_read_b128 v[128:131], v15 offset:0
    ds_read_b64_tr_b16 v[136:137], v20 offset:2048
    v_mfma_f32_32x32x16_bf16 v[64:79], v[148:151], v[152:155], v[64:79]
    ds_read_b64_tr_b16 v[138:139], v20 offset:2560
    ds_read_b128 v[132:135], v15 offset:4096
    v_mfma_f32_32x32x16_bf16 v[80:95], v[144:147], v[156:159], v[80:95]
    ds_read_b64_tr_b16 v[140:141], v21 offset:2048
    ds_read_b64_tr_b16 v[142:143], v21 offset:2560
    v_mfma_f32_32x32x16_bf16 v[96:111], v[148:151], v[156:159], v[96:111]
    s_waitcnt lgkmcnt(6)
    v_mfma_f32_32x32x16_bf16 v[48:63], v[112:115], v[120:123], v[48:63]
    ds_read_b128 v[144:147], v16 offset:0
    ds_read_b64_tr_b16 v[152:153], v20 offset:4096
    v_mfma_f32_32x32x16_bf16 v[64:79], v[116:119], v[120:123], v[64:79]
    ds_read_b64_tr_b16 v[154:155], v20 offset:4608
    ds_read_b128 v[148:151], v16 offset:4096
    v_mfma_f32_32x32x16_bf16 v[80:95], v[112:115], v[124:127], v[80:95]
    ds_read_b64_tr_b16 v[156:157], v21 offset:4096
    ds_read_b64_tr_b16 v[158:159], v21 offset:4608
    v_mfma_f32_32x32x16_bf16 v[96:111], v[116:119], v[124:127], v[96:111]
    s_waitcnt lgkmcnt(6)
    v_mfma_f32_32x32x16_bf16 v[48:63], v[128:131], v[136:139], v[48:63]
    ds_read_b128 v[112:115], v17 offset:0
    ds_read_b64_tr_b16 v[120:121], v20 offset:6144
    v_mfma_f32_32x32x16_bf16 v[64:79], v[132:135], v[136:139], v[64:79]
    ds_read_b64_tr_b16 v[122:123], v20 offset:6656
    ds_read_b128 v[116:119], v17 offset:4096
    v_mfma_f32_32x32x16_bf16 v[80:95], v[128:131], v[140:143], v[80:95]
    ds_read_b64_tr_b16 v[124:125], v21 offset:6144
    ds_read_b64_tr_b16 v[126:127], v21 offset:6656
    v_mfma_f32_32x32x16_bf16 v[96:111], v[132:135], v[140:143], v[96:111]
    s_barrier
    s_waitcnt lgkmcnt(6)
    v_mfma_f32_32x32x16_bf16 v[48:63], v[144:147], v[152:155], v[48:63]
    ds_read_b128 v[128:131], v14 offset:32768
    ds_read_b64_tr_b16 v[136:137], v20 offset:32768
    v_mfma_f32_32x32x16_bf16 v[64:79], v[148:151], v[152:155], v[64:79]
    ds_read_b64_tr_b16 v[138:139], v20 offset:33280
    ds_read_b128 v[132:135], v14 offset:36864
    v_mfma_f32_32x32x16_bf16 v[80:95], v[144:147], v[156:159], v[80:95]
    ds_read_b64_tr_b16 v[140:141], v21 offset:32768
    ds_read_b64_tr_b16 v[142:143], v21 offset:33280
    v_mfma_f32_32x32x16_bf16 v[96:111], v[148:151], v[156:159], v[96:111]
    s_waitcnt lgkmcnt(6)
    v_mfma_f32_32x32x16_bf16 v[48:63], v[112:115], v[120:123], v[48:63]
    ds_read_b128 v[144:147], v15 offset:32768
    ds_read_b64_tr_b16 v[152:153], v20 offset:34816
    v_mfma_f32_32x32x16_bf16 v[64:79], v[116:119], v[120:123], v[64:79]
    ds_read_b64_tr_b16 v[154:155], v20 offset:35328
    ds_read_b128 v[148:151], v15 offset:36864
    v_mfma_f32_32x32x16_bf16 v[80:95], v[112:115], v[124:127], v[80:95]
    ds_read_b64_tr_b16 v[156:157], v21 offset:34816
    ds_read_b64_tr_b16 v[158:159], v21 offset:35328
    v_mfma_f32_32x32x16_bf16 v[96:111], v[116:119], v[124:127], v[96:111]
    s_waitcnt lgkmcnt(6)
    v_mfma_f32_32x32x16_bf16 v[48:63], v[128:131], v[136:139], v[48:63]
    ds_read_b128 v[112:115], v16 offset:32768
    ds_read_b64_tr_b16 v[120:121], v20 offset:36864
    v_mfma_f32_32x32x16_bf16 v[64:79], v[132:135], v[136:139], v[64:79]
    ds_read_b64_tr_b16 v[122:123], v20 offset:37376
    ds_read_b128 v[116:119], v16 offset:36864
    v_mfma_f32_32x32x16_bf16 v[80:95], v[128:131], v[140:143], v[80:95]
    ds_read_b64_tr_b16 v[124:125], v21 offset:36864
    ds_read_b64_tr_b16 v[126:127], v21 offset:37376
    v_mfma_f32_32x32x16_bf16 v[96:111], v[132:135], v[140:143], v[96:111]
    s_waitcnt lgkmcnt(6)
    v_mfma_f32_32x32x16_bf16 v[48:63], v[144:147], v[152:155], v[48:63]
    ds_read_b128 v[128:131], v17 offset:32768
    ds_read_b64_tr_b16 v[136:137], v20 offset:38912
    v_mfma_f32_32x32x16_bf16 v[64:79], v[148:151], v[152:155], v[64:79]
    ds_read_b64_tr_b16 v[138:139], v20 offset:39424
    ds_read_b128 v[132:135], v17 offset:36864
    v_mfma_f32_32x32x16_bf16 v[80:95], v[144:147], v[156:159], v[80:95]
    ds_read_b64_tr_b16 v[140:141], v21 offset:38912
    ds_read_b64_tr_b16 v[142:143], v21 offset:39424
    v_mfma_f32_32x32x16_bf16 v[96:111], v[148:151], v[156:159], v[96:111]
    s_waitcnt lgkmcnt(6)
    v_mfma_f32_32x32x16_bf16 v[48:63], v[112:115], v[120:123], v[48:63]
    v_mfma_f32_32x32x16_bf16 v[64:79], v[116:119], v[120:123], v[64:79]
    v_mfma_f32_32x32x16_bf16 v[80:95], v[112:115], v[124:127], v[80:95]
    v_mfma_f32_32x32x16_bf16 v[96:111], v[116:119], v[124:127], v[96:111]
    s_waitcnt lgkmcnt(0)
    v_mfma_f32_32x32x16_bf16 v[48:63], v[128:131], v[136:139], v[48:63]
    v_mfma_f32_32x32x16_bf16 v[64:79], v[132:135], v[136:139], v[64:79]
    v_mfma_f32_32x32x16_bf16 v[80:95], v[128:131], v[140:143], v[80:95]
    v_mfma_f32_32x32x16_bf16 v[96:111], v[132:135], v[140:143], v[96:111]
    v_mov_b32 v32, 137472
    ds_read_b64 v[166:167], v32
    s_mov_b32 s59, s63
    s_add_u32 s60, s59, s64
    s_nop 4
    v_cvt_pk_bf16_f32 v112, v48, v49
    v_cvt_pk_bf16_f32 v113, v50, v51
    v_cvt_pk_bf16_f32 v114, v52, v53
    v_cvt_pk_bf16_f32 v115, v54, v55
    buffer_store_dwordx4 v[112:115], v9, s[28:31], s59 offen offset:1024 sc1
    v_cvt_pk_bf16_f32 v116, v56, v57
    v_cvt_pk_bf16_f32 v117, v58, v59
    v_cvt_pk_bf16_f32 v118, v60, v61
    v_cvt_pk_bf16_f32 v119, v62, v63
    buffer_store_dwordx4 v[116:119], v9, s[28:31], s59 offen offset:1536 sc1
    s_add_u32 s59, s63, s65
    s_add_u32 s60, s59, s64
    v_cvt_pk_bf16_f32 v120, v64, v65
    v_cvt_pk_bf16_f32 v121, v66, v67
    v_cvt_pk_bf16_f32 v122, v68, v69
    v_cvt_pk_bf16_f32 v123, v70, v71
    buffer_store_dwordx4 v[120:123], v9, s[28:31], s59 offen offset:1024 sc1
    v_cvt_pk_bf16_f32 v124, v72, v73
    v_cvt_pk_bf16_f32 v125, v74, v75
    v_cvt_pk_bf16_f32 v126, v76, v77
    v_cvt_pk_bf16_f32 v127, v78, v79
    buffer_store_dwordx4 v[124:127], v9, s[28:31], s59 offen offset:1536 sc1
    s_lshl_b32 s60, s64, 1
    s_add_u32 s63, s63, s60
    s_mov_b32 s59, s63
    s_add_u32 s60, s59, s64
    v_cvt_pk_bf16_f32 v128, v80, v81
    v_cvt_pk_bf16_f32 v129, v82, v83
    v_cvt_pk_bf16_f32 v130, v84, v85
    v_cvt_pk_bf16_f32 v131, v86, v87
    buffer_store_dwordx4 v[128:131], v9, s[28:31], s59 offen offset:1024 sc1
    v_cvt_pk_bf16_f32 v132, v88, v89
    v_cvt_pk_bf16_f32 v133, v90, v91
    v_cvt_pk_bf16_f32 v134, v92, v93
    v_cvt_pk_bf16_f32 v135, v94, v95
    buffer_store_dwordx4 v[132:135], v9, s[28:31], s59 offen offset:1536 sc1
    s_add_u32 s59, s63, s65
    s_add_u32 s60, s59, s64
    v_cvt_pk_bf16_f32 v136, v96, v97
    v_cvt_pk_bf16_f32 v137, v98, v99
    v_cvt_pk_bf16_f32 v138, v100, v101
    v_cvt_pk_bf16_f32 v139, v102, v103
    buffer_store_dwordx4 v[136:139], v9, s[28:31], s59 offen offset:1024 sc1
    v_cvt_pk_bf16_f32 v140, v104, v105
    v_cvt_pk_bf16_f32 v141, v106, v107
    v_cvt_pk_bf16_f32 v142, v108, v109
    v_cvt_pk_bf16_f32 v143, v110, v111
    buffer_store_dwordx4 v[140:143], v9, s[28:31], s59 offen offset:1536 sc1
P1_PUB:
    ds_write_b32 v31, v30 offset:128
    s_waitcnt lgkmcnt(0)
    v_lshlrev_b32 v32, 20, v1
    s_waitcnt vmcnt(0)
    buffer_store_dwordx2 v[166:167], v32, s[36:39], s62 offen sc1
    ds_write_b32 v31, v30
    s_branch ATT
SVC:
    s_lshl_b32 s56, s52, 3
    s_and_b32 s57, s53, 7
    s_add_u32 s56, s56, s57
    s_lshl_b32 s56, s56, 3
    s_add_u32 s56, s56, s3
    s_lshl_b32 s57, s56, 12
    v_lshlrev_b32 v2, 4, v1
    s_waitcnt lgkmcnt(0)
    s_mov_b32 s28, s4
    s_mov_b32 s29, s5
    s_mov_b32 s30, 0x200000
    s_mov_b32 s31, 0x20000
    s_mov_b32 s32, s20
    s_mov_b32 s33, s21
    s_mov_b32 s34, 0x400
    s_mov_b32 s35, 0x20000
    buffer_load_dwordx4 v[4:7], v2, s[28:31], s57 offen offset:0
    buffer_load_dwordx4 v[8:11], v2, s[28:31], s57 offen offset:1024
    buffer_load_dwordx4 v[12:15], v2, s[28:31], s57 offen offset:2048
    buffer_load_dwordx4 v[16:19], v2, s[28:31], s57 offen offset:3072
    buffer_load_dwordx4 v[20:23], v2, s[32:35], 0 offen
    s_add_u32 s28, s26, 0x600000
    s_addc_u32 s29, s27, 0
    s_mov_b32 s30, 0x200000
    s_mov_b32 s31, 0x20000
    s_add_u32 s32, s26, 0xe00000
    s_addc_u32 s33, s27, 0
    s_mov_b32 s34, 0x2000
    s_mov_b32 s35, 0x20000
    s_add_u32 s36, s26, 0xf00000
    s_addc_u32 s37, s27, 0
    s_mov_b32 s38, 0xc0000
    s_mov_b32 s39, 0x20000
    s_mov_b32 s59, 0xffff0000
    s_lshr_b32 s60, s3, 1
    s_lshl_b32 s60, s60, 13
    s_add_u32 s60, s60, 65536
    s_and_b32 s61, s3, 1
    s_lshl_b32 s62, s61, 3
    s_add_u32 s62, s62, s60
    s_lshl_b32 s61, s61, 12
    s_add_u32 s61, s61, s60
    v_lshlrev_b32 v72, 7, v1
    v_and_b32 v73, 7, v1
    v_lshl_add_u32 v72, v73, 4, v72
    v_add_u32 v72, s62, v72
    v_lshrrev_b32 v74, 3, v1
    v_xor_b32 v73, v73, v74
    v_lshlrev_b32 v74, 7, v74
    v_lshl_add_u32 v73, v73, 4, v74
    v_add_u32 v73, s61, v73
    s_waitcnt vmcnt(0)
    v_lshlrev_b32 v56, 16, v20
    v_and_b32 v57, s59, v20
    v_lshlrev_b32 v58, 16, v21
    v_and_b32 v59, s59, v21
    v_lshlrev_b32 v60, 16, v22
    v_and_b32 v61, s59, v22
    v_lshlrev_b32 v62, 16, v23
    v_and_b32 v63, s59, v23
    v_lshlrev_b32 v24, 16, v4
    v_and_b32 v25, s59, v4
    v_lshlrev_b32 v26, 16, v5
    v_and_b32 v27, s59, v5
    v_lshlrev_b32 v28, 16, v6
    v_and_b32 v29, s59, v6
    v_lshlrev_b32 v30, 16, v7
    v_and_b32 v31, s59, v7
    v_lshlrev_b32 v32, 16, v8
    v_and_b32 v33, s59, v8
    v_lshlrev_b32 v34, 16, v9
    v_and_b32 v35, s59, v9
    v_lshlrev_b32 v36, 16, v10
    v_and_b32 v37, s59, v10
    v_lshlrev_b32 v38, 16, v11
    v_and_b32 v39, s59, v11
    v_lshlrev_b32 v40, 16, v12
    v_and_b32 v41, s59, v12
    v_lshlrev_b32 v42, 16, v13
    v_and_b32 v43, s59, v13
    v_lshlrev_b32 v44, 16, v14
    v_and_b32 v45, s59, v14
    v_lshlrev_b32 v46, 16, v15
    v_and_b32 v47, s59, v15
    v_lshlrev_b32 v48, 16, v16
    v_and_b32 v49, s59, v16
    v_lshlrev_b32 v50, 16, v17
    v_and_b32 v51, s59, v17
    v_lshlrev_b32 v52, 16, v18
    v_and_b32 v53, s59, v18
    v_lshlrev_b32 v54, 16, v19
    v_and_b32 v55, s59, v19
    v_pk_add_f32 v[4:5], v[24:25], v[26:27]
    v_pk_mul_f32 v[6:7], v[24:25], v[56:57]
    v_pk_add_f32 v[8:9], v[32:33], v[34:35]
    v_pk_mul_f32 v[10:11], v[32:33], v[56:57]
    v_pk_add_f32 v[12:13], v[40:41], v[42:43]
    v_pk_mul_f32 v[14:15], v[40:41], v[56:57]
    v_pk_add_f32 v[16:17], v[48:49], v[50:51]
    v_pk_mul_f32 v[18:19], v[48:49], v[56:57]
    v_pk_fma_f32 v[6:7], v[26:27], v[58:59], v[6:7]
    v_pk_fma_f32 v[10:11], v[34:35], v[58:59], v[10:11]
    v_pk_fma_f32 v[14:15], v[42:43], v[58:59], v[14:15]
    v_pk_fma_f32 v[18:19], v[50:51], v[58:59], v[18:19]
    v_pk_add_f32 v[4:5], v[4:5], v[28:29]
    v_pk_fma_f32 v[6:7], v[28:29], v[60:61], v[6:7]
    v_pk_add_f32 v[8:9], v[8:9], v[36:37]
    v_pk_fma_f32 v[10:11], v[36:37], v[60:61], v[10:11]
    v_pk_add_f32 v[12:13], v[12:13], v[44:45]
    v_pk_fma_f32 v[14:15], v[44:45], v[60:61], v[14:15]
    v_pk_add_f32 v[16:17], v[16:17], v[52:53]
    v_pk_fma_f32 v[18:19], v[52:53], v[60:61], v[18:19]
    v_pk_add_f32 v[4:5], v[4:5], v[30:31]
    v_pk_fma_f32 v[6:7], v[30:31], v[62:63], v[6:7]
    v_pk_add_f32 v[8:9], v[8:9], v[38:39]
    v_pk_fma_f32 v[10:11], v[38:39], v[62:63], v[10:11]
    v_pk_add_f32 v[12:13], v[12:13], v[46:47]
    v_pk_fma_f32 v[14:15], v[46:47], v[62:63], v[14:15]
    v_pk_add_f32 v[16:17], v[16:17], v[54:55]
    v_pk_fma_f32 v[18:19], v[54:55], v[62:63], v[18:19]
    v_add_f32 v64, v4, v5
    v_add_f32 v68, v6, v7
    v_add_f32 v65, v8, v9
    v_add_f32 v69, v10, v11
    v_add_f32 v66, v12, v13
    v_add_f32 v70, v14, v15
    v_add_f32 v67, v16, v17
    v_add_f32 v71, v18, v19
    v_add_f32_dpp v64, v64, v64 row_shr:1 row_mask:0xf bank_mask:0xf
    v_add_f32_dpp v65, v65, v65 row_shr:1 row_mask:0xf bank_mask:0xf
    v_add_f32_dpp v66, v66, v66 row_shr:1 row_mask:0xf bank_mask:0xf
    v_add_f32_dpp v67, v67, v67 row_shr:1 row_mask:0xf bank_mask:0xf
    v_add_f32_dpp v64, v64, v64 row_shr:2 row_mask:0xf bank_mask:0xf
    v_add_f32_dpp v65, v65, v65 row_shr:2 row_mask:0xf bank_mask:0xf
    v_add_f32_dpp v66, v66, v66 row_shr:2 row_mask:0xf bank_mask:0xf
    v_add_f32_dpp v67, v67, v67 row_shr:2 row_mask:0xf bank_mask:0xf
    v_add_f32_dpp v64, v64, v64 row_shr:4 row_mask:0xf bank_mask:0xf
    v_add_f32_dpp v65, v65, v65 row_shr:4 row_mask:0xf bank_mask:0xf
    v_add_f32_dpp v66, v66, v66 row_shr:4 row_mask:0xf bank_mask:0xf
    v_add_f32_dpp v67, v67, v67 row_shr:4 row_mask:0xf bank_mask:0xf
    v_add_f32_dpp v64, v64, v64 row_shr:8 row_mask:0xf bank_mask:0xf
    v_add_f32_dpp v65, v65, v65 row_shr:8 row_mask:0xf bank_mask:0xf
    v_add_f32_dpp v66, v66, v66 row_shr:8 row_mask:0xf bank_mask:0xf
    v_add_f32_dpp v67, v67, v67 row_shr:8 row_mask:0xf bank_mask:0xf
    v_add_f32_dpp v64, v64, v64 row_bcast:15 row_mask:0xa bank_mask:0xf
    v_add_f32_dpp v65, v65, v65 row_bcast:15 row_mask:0xa bank_mask:0xf
    v_add_f32_dpp v66, v66, v66 row_bcast:15 row_mask:0xa bank_mask:0xf
    v_add_f32_dpp v67, v67, v67 row_bcast:15 row_mask:0xa bank_mask:0xf
    v_add_f32_dpp v64, v64, v64 row_bcast:31 row_mask:0xc bank_mask:0xf
    v_add_f32_dpp v65, v65, v65 row_bcast:31 row_mask:0xc bank_mask:0xf
    v_add_f32_dpp v66, v66, v66 row_bcast:31 row_mask:0xc bank_mask:0xf
    v_add_f32_dpp v67, v67, v67 row_bcast:31 row_mask:0xc bank_mask:0xf
    v_mul_f32 v64, 0x3b000000, v64
    v_mul_f32 v65, 0x3b000000, v65
    v_mul_f32 v66, 0x3b000000, v66
    v_mul_f32 v67, 0x3b000000, v67
    v_readlane_b32 s40, v64, 63
    v_readlane_b32 s41, v65, 63
    v_readlane_b32 s42, v66, 63
    v_readlane_b32 s43, v67, 63
    v_subrev_f32 v24, s40, v24
    v_subrev_f32 v32, s41, v32
    v_subrev_f32 v40, s42, v40
    v_subrev_f32 v48, s43, v48
    v_subrev_f32 v25, s40, v25
    v_subrev_f32 v33, s41, v33
    v_subrev_f32 v41, s42, v41
    v_subrev_f32 v49, s43, v49
    v_subrev_f32 v26, s40, v26
    v_subrev_f32 v34, s41, v34
    v_subrev_f32 v42, s42, v42
    v_subrev_f32 v50, s43, v50
    v_subrev_f32 v27, s40, v27
    v_subrev_f32 v35, s41, v35
    v_subrev_f32 v43, s42, v43
    v_subrev_f32 v51, s43, v51
    v_subrev_f32 v28, s40, v28
    v_subrev_f32 v36, s41, v36
    v_subrev_f32 v44, s42, v44
    v_subrev_f32 v52, s43, v52
    v_subrev_f32 v29, s40, v29
    v_subrev_f32 v37, s41, v37
    v_subrev_f32 v45, s42, v45
    v_subrev_f32 v53, s43, v53
    v_subrev_f32 v30, s40, v30
    v_subrev_f32 v38, s41, v38
    v_subrev_f32 v46, s42, v46
    v_subrev_f32 v54, s43, v54
    v_subrev_f32 v31, s40, v31
    v_subrev_f32 v39, s41, v39
    v_subrev_f32 v47, s42, v47
    v_subrev_f32 v55, s43, v55
    v_pk_mul_f32 v[4:5], v[24:25], v[24:25]
    v_pk_mul_f32 v[8:9], v[32:33], v[32:33]
    v_pk_mul_f32 v[12:13], v[40:41], v[40:41]
    v_pk_mul_f32 v[16:17], v[48:49], v[48:49]
    v_pk_fma_f32 v[4:5], v[26:27], v[26:27], v[4:5]
    v_pk_fma_f32 v[8:9], v[34:35], v[34:35], v[8:9]
    v_pk_fma_f32 v[12:13], v[42:43], v[42:43], v[12:13]
    v_pk_fma_f32 v[16:17], v[50:51], v[50:51], v[16:17]
    v_pk_fma_f32 v[4:5], v[28:29], v[28:29], v[4:5]
    v_pk_fma_f32 v[8:9], v[36:37], v[36:37], v[8:9]
    v_pk_fma_f32 v[12:13], v[44:45], v[44:45], v[12:13]
    v_pk_fma_f32 v[16:17], v[52:53], v[52:53], v[16:17]
    v_pk_fma_f32 v[4:5], v[30:31], v[30:31], v[4:5]
    v_pk_fma_f32 v[8:9], v[38:39], v[38:39], v[8:9]
    v_pk_fma_f32 v[12:13], v[46:47], v[46:47], v[12:13]
    v_pk_fma_f32 v[16:17], v[54:55], v[54:55], v[16:17]
    v_add_f32 v64, v4, v5
    v_add_f32 v65, v8, v9
    v_add_f32 v66, v12, v13
    v_add_f32 v67, v16, v17
    v_add_f32_dpp v64, v64, v64 row_shr:1 row_mask:0xf bank_mask:0xf
    v_add_f32_dpp v65, v65, v65 row_shr:1 row_mask:0xf bank_mask:0xf
    v_add_f32_dpp v66, v66, v66 row_shr:1 row_mask:0xf bank_mask:0xf
    v_add_f32_dpp v67, v67, v67 row_shr:1 row_mask:0xf bank_mask:0xf
    v_add_f32_dpp v64, v64, v64 row_shr:2 row_mask:0xf bank_mask:0xf
    v_add_f32_dpp v65, v65, v65 row_shr:2 row_mask:0xf bank_mask:0xf
    v_add_f32_dpp v66, v66, v66 row_shr:2 row_mask:0xf bank_mask:0xf
    v_add_f32_dpp v67, v67, v67 row_shr:2 row_mask:0xf bank_mask:0xf
    v_add_f32_dpp v64, v64, v64 row_shr:4 row_mask:0xf bank_mask:0xf
    v_add_f32_dpp v65, v65, v65 row_shr:4 row_mask:0xf bank_mask:0xf
    v_add_f32_dpp v66, v66, v66 row_shr:4 row_mask:0xf bank_mask:0xf
    v_add_f32_dpp v67, v67, v67 row_shr:4 row_mask:0xf bank_mask:0xf
    v_add_f32_dpp v64, v64, v64 row_shr:8 row_mask:0xf bank_mask:0xf
    v_add_f32_dpp v65, v65, v65 row_shr:8 row_mask:0xf bank_mask:0xf
    v_add_f32_dpp v66, v66, v66 row_shr:8 row_mask:0xf bank_mask:0xf
    v_add_f32_dpp v67, v67, v67 row_shr:8 row_mask:0xf bank_mask:0xf
    v_add_f32_dpp v64, v64, v64 row_bcast:15 row_mask:0xa bank_mask:0xf
    v_add_f32_dpp v65, v65, v65 row_bcast:15 row_mask:0xa bank_mask:0xf
    v_add_f32_dpp v66, v66, v66 row_bcast:15 row_mask:0xa bank_mask:0xf
    v_add_f32_dpp v67, v67, v67 row_bcast:15 row_mask:0xa bank_mask:0xf
    v_add_f32_dpp v64, v64, v64 row_bcast:31 row_mask:0xc bank_mask:0xf
    v_add_f32_dpp v65, v65, v65 row_bcast:31 row_mask:0xc bank_mask:0xf
    v_add_f32_dpp v66, v66, v66 row_bcast:31 row_mask:0xc bank_mask:0xf
    v_add_f32_dpp v67, v67, v67 row_bcast:31 row_mask:0xc bank_mask:0xf
    v_mov_b32 v3, 0x3727c5ac
    s_mov_b32 s60, 0x3b000000
    v_fma_f32 v64, v64, s60, v3
    v_fma_f32 v65, v65, s60, v3
    v_fma_f32 v66, v66, s60, v3
    v_fma_f32 v67, v67, s60, v3
    v_rsq_f32 v64, v64
    v_rsq_f32 v65, v65
    v_rsq_f32 v66, v66
    v_rsq_f32 v67, v67
    s_nop 0
    v_readlane_b32 s40, v64, 63
    v_readlane_b32 s41, v65, 63
    v_readlane_b32 s42, v66, 63
    v_readlane_b32 s43, v67, 63
    v_mul_f32 v24, s40, v24
    v_mul_f32 v32, s41, v32
    v_mul_f32 v40, s42, v40
    v_mul_f32 v48, s43, v48
    v_cvt_pk_bf16_f32 v4, v24, v32
    v_cvt_pk_bf16_f32 v5, v40, v48
    v_xor_b32 v56, 0, v72
    ds_write_b64 v56, v[4:5]
    v_mul_f32 v25, s40, v25
    v_mul_f32 v33, s41, v33
    v_mul_f32 v41, s42, v41
    v_mul_f32 v49, s43, v49
    v_cvt_pk_bf16_f32 v6, v25, v33
    v_cvt_pk_bf16_f32 v7, v41, v49
    v_xor_b32 v57, 16, v72
    ds_write_b64 v57, v[6:7]
    v_mul_f32 v26, s40, v26
    v_mul_f32 v34, s41, v34
    v_mul_f32 v42, s42, v42
    v_mul_f32 v50, s43, v50
    v_cvt_pk_bf16_f32 v8, v26, v34
    v_cvt_pk_bf16_f32 v9, v42, v50
    v_xor_b32 v58, 32, v72
    ds_write_b64 v58, v[8:9]
    v_mul_f32 v27, s40, v27
    v_mul_f32 v35, s41, v35
    v_mul_f32 v43, s42, v43
    v_mul_f32 v51, s43, v51
    v_cvt_pk_bf16_f32 v10, v27, v35
    v_cvt_pk_bf16_f32 v11, v43, v51
    v_xor_b32 v59, 48, v72
    ds_write_b64 v59, v[10:11]
    v_mul_f32 v28, s40, v28
    v_mul_f32 v36, s41, v36
    v_mul_f32 v44, s42, v44
    v_mul_f32 v52, s43, v52
    v_cvt_pk_bf16_f32 v12, v28, v36
    v_cvt_pk_bf16_f32 v13, v44, v52
    v_xor_b32 v60, 64, v72
    ds_write_b64 v60, v[12:13]
    v_mul_f32 v29, s40, v29
    v_mul_f32 v37, s41, v37
    v_mul_f32 v45, s42, v45
    v_mul_f32 v53, s43, v53
    v_cvt_pk_bf16_f32 v14, v29, v37
    v_cvt_pk_bf16_f32 v15, v45, v53
    v_xor_b32 v61, 80, v72
    ds_write_b64 v61, v[14:15]
    v_mul_f32 v30, s40, v30
    v_mul_f32 v38, s41, v38
    v_mul_f32 v46, s42, v46
    v_mul_f32 v54, s43, v54
    v_cvt_pk_bf16_f32 v16, v30, v38
    v_cvt_pk_bf16_f32 v17, v46, v54
    v_xor_b32 v62, 96, v72
    ds_write_b64 v62, v[16:17]
    v_mul_f32 v31, s40, v31
    v_mul_f32 v39, s41, v39
    v_mul_f32 v47, s42, v47
    v_mul_f32 v55, s43, v55
    v_cvt_pk_bf16_f32 v18, v31, v39
    v_cvt_pk_bf16_f32 v19, v47, v55
    v_xor_b32 v63, 112, v72
    ds_write_b64 v63, v[18:19]
    s_waitcnt lgkmcnt(0)
    s_barrier
    ds_read_b128 v[24:27], v73 offset:0
    ds_read_b128 v[28:31], v73 offset:1024
    ds_read_b128 v[32:35], v73 offset:2048
    ds_read_b128 v[36:39], v73 offset:3072
    v_mov_b32 v3, 137472
    ds_read_b64 v[166:167], v3
    s_waitcnt lgkmcnt(4)
    buffer_store_dwordx4 v[24:27], v2, s[28:31], s57 offen offset:0 sc1
    s_waitcnt lgkmcnt(3)
    buffer_store_dwordx4 v[28:31], v2, s[28:31], s57 offen offset:1024 sc1
    s_waitcnt lgkmcnt(2)
    buffer_store_dwordx4 v[32:35], v2, s[28:31], s57 offen offset:2048 sc1
    s_waitcnt lgkmcnt(1)
    buffer_store_dwordx4 v[36:39], v2, s[28:31], s57 offen offset:3072 sc1
    v_add_f32_dpp v68, v68, v68 row_shr:1 row_mask:0xf bank_mask:0xf
    v_add_f32_dpp v69, v69, v69 row_shr:1 row_mask:0xf bank_mask:0xf
    v_add_f32_dpp v70, v70, v70 row_shr:1 row_mask:0xf bank_mask:0xf
    v_add_f32_dpp v71, v71, v71 row_shr:1 row_mask:0xf bank_mask:0xf
    v_add_f32_dpp v68, v68, v68 row_shr:2 row_mask:0xf bank_mask:0xf
    v_add_f32_dpp v69, v69, v69 row_shr:2 row_mask:0xf bank_mask:0xf
    v_add_f32_dpp v70, v70, v70 row_shr:2 row_mask:0xf bank_mask:0xf
    v_add_f32_dpp v71, v71, v71 row_shr:2 row_mask:0xf bank_mask:0xf
    v_add_f32_dpp v68, v68, v68 row_shr:4 row_mask:0xf bank_mask:0xf
    v_add_f32_dpp v69, v69, v69 row_shr:4 row_mask:0xf bank_mask:0xf
    v_add_f32_dpp v70, v70, v70 row_shr:4 row_mask:0xf bank_mask:0xf
    v_add_f32_dpp v71, v71, v71 row_shr:4 row_mask:0xf bank_mask:0xf
    v_add_f32_dpp v68, v68, v68 row_shr:8 row_mask:0xf bank_mask:0xf
    v_add_f32_dpp v69, v69, v69 row_shr:8 row_mask:0xf bank_mask:0xf
    v_add_f32_dpp v70, v70, v70 row_shr:8 row_mask:0xf bank_mask:0xf
    v_add_f32_dpp v71, v71, v71 row_shr:8 row_mask:0xf bank_mask:0xf
    v_add_f32_dpp v68, v68, v68 row_bcast:15 row_mask:0xa bank_mask:0xf
    v_add_f32_dpp v69, v69, v69 row_bcast:15 row_mask:0xa bank_mask:0xf
    v_add_f32_dpp v70, v70, v70 row_bcast:15 row_mask:0xa bank_mask:0xf
    v_add_f32_dpp v71, v71, v71 row_bcast:15 row_mask:0xa bank_mask:0xf
    v_add_f32_dpp v68, v68, v68 row_bcast:31 row_mask:0xc bank_mask:0xf
    v_add_f32_dpp v69, v69, v69 row_bcast:31 row_mask:0xc bank_mask:0xf
    v_add_f32_dpp v70, v70, v70 row_bcast:31 row_mask:0xc bank_mask:0xf
    v_add_f32_dpp v71, v71, v71 row_bcast:31 row_mask:0xc bank_mask:0xf
    v_mul_f32 v68, 0xbfb8aa3b, v68
    v_mul_f32 v69, 0xbfb8aa3b, v69
    v_mul_f32 v70, 0xbfb8aa3b, v70
    v_mul_f32 v71, 0xbfb8aa3b, v71
    v_exp_f32 v68, v68
    v_exp_f32 v69, v69
    v_exp_f32 v70, v70
    v_exp_f32 v71, v71
    v_add_f32 v68, 1.0, v68
    v_add_f32 v69, 1.0, v69
    v_add_f32 v70, 1.0, v70
    v_add_f32 v71, 1.0, v71
    v_rcp_f32 v68, v68
    v_rcp_f32 v69, v69
    v_rcp_f32 v70, v70
    v_rcp_f32 v71, v71
    s_lshl_b32 s60, s56, 4
    v_mov_b32 v3, 0
    s_mov_b32 exec_lo, 0
    s_mov_b32 exec_hi, 0x80000000
    buffer_store_dwordx4 v[68:71], v3, s[32:35], s60 offen sc1
    s_mov_b64 exec, -1
    s_waitcnt vmcnt(0) lgkmcnt(0)
    s_barrier
    s_cmp_lg_u32 s3, 0
    s_cbranch_scc1 SVC_P
    s_lshl_b32 s60, s56, 4
    v_lshlrev_b32 v3, 20, v1
    s_waitcnt vmcnt(0)
    buffer_store_dwordx2 v[166:167], v3, s[36:39], s60 offen sc1
SVC_P:
    s_barrier
    s_branch L_TAIL
P1_LOAD:
    s_sub_u32 s59, s3, 4
    v_lshrrev_b32 v2, 3, v1
    v_and_b32 v3, 7, v1
    v_lshrrev_b32 v20, 4, v1
    v_xor_b32 v3, v3, v20
    v_lshlrev_b32 v2, 10, v2
    v_lshl_add_u32 v4, v3, 4, v2
    v_xor_b32 v3, 4, v3
    v_lshl_add_u32 v5, v3, 4, v2
    v_add_u32 v5, 8192, v5
    v_add_u32 v6, 16384, v4
    v_add_u32 v7, 16384, v5
    v_lshrrev_b32 v2, 3, v1
    v_mul_u32_u24 v2, 3072, v2
    v_bfe_u32 v3, v1, 4, 1
    v_lshlrev_b32 v3, 2, v3
    v_xor_b32 v3, v3, v1
    v_and_b32 v3, 7, v3
    v_lshl_add_u32 v8, v3, 4, v2
    v_add_u32 v9, 24576, v8
    s_lshl_b32 s60, s54, 17
    s_lshl_b32 s61, s59, 15
    s_add_u32 s60, s60, s61
    s_mul_i32 s61, s59, 49152
    s_lshl_b32 s62, s55, 8
    s_add_u32 s61, s61, s62
    s_lshl_b32 s62, s59, 12
    s_lshl_b32 s65, s59, 11
    s_waitcnt lgkmcnt(0)
    s_mov_b32 s28, s4
    s_mov_b32 s29, s5
    s_mov_b32 s30, 0x200000
    s_mov_b32 s31, 0x20000
    s_mov_b32 s32, s6
    s_mov_b32 s33, s7
    s_mov_b32 s34, 0x180000
    s_mov_b32 s35, 0x20000
    s_and_b32 s58, s58, 7
    s_lshl_b32 s63, s58, 7
    s_add_u32 s63, s63, s60
    s_mul_i32 s64, s58, 196608
    s_add_u32 s64, s64, s61
    s_add_u32 s58, s58, 1
    s_add_u32 m0, s62, 0
    s_nop 0
    buffer_load_dwordx4 v4, s[28:31], s63 offen lds
    s_add_u32 m0, s62, 1024
    s_nop 0
    buffer_load_dwordx4 v5, s[28:31], s63 offen lds
    s_add_u32 m0, s62, 2048
    s_nop 0
    buffer_load_dwordx4 v6, s[28:31], s63 offen lds
    s_add_u32 m0, s62, 3072
    s_nop 0
    buffer_load_dwordx4 v7, s[28:31], s63 offen lds
    s_add_u32 m0, s65, 16384
    s_nop 0
    buffer_load_dwordx4 v8, s[32:35], s64 offen offset:0 lds
    s_add_u32 m0, s65, 24448
    s_nop 0
    buffer_load_dwordx4 v8, s[32:35], s64 offen offset:128 lds
    s_add_u32 m0, s65, 17408
    s_nop 0
    buffer_load_dwordx4 v9, s[32:35], s64 offen offset:0 lds
    s_add_u32 m0, s65, 25472
    s_nop 0
    buffer_load_dwordx4 v9, s[32:35], s64 offen offset:128 lds
    s_waitcnt vmcnt(4)
    s_and_b32 s58, s58, 7
    s_lshl_b32 s63, s58, 7
    s_add_u32 s63, s63, s60
    s_mul_i32 s64, s58, 196608
    s_add_u32 s64, s64, s61
    s_add_u32 s58, s58, 1
    s_add_u32 m0, s62, 32768
    s_nop 0
    buffer_load_dwordx4 v4, s[28:31], s63 offen lds
    s_add_u32 m0, s62, 33792
    s_nop 0
    buffer_load_dwordx4 v5, s[28:31], s63 offen lds
    s_add_u32 m0, s62, 34816
    s_nop 0
    buffer_load_dwordx4 v6, s[28:31], s63 offen lds
    s_add_u32 m0, s62, 35840
    s_nop 0
    buffer_load_dwordx4 v7, s[28:31], s63 offen lds
    s_add_u32 m0, s65, 49152
    s_nop 0
    buffer_load_dwordx4 v8, s[32:35], s64 offen offset:0 lds
    s_add_u32 m0, s65, 57216
    s_nop 0
    buffer_load_dwordx4 v8, s[32:35], s64 offen offset:128 lds
    s_add_u32 m0, s65, 50176
    s_nop 0
    buffer_load_dwordx4 v9, s[32:35], s64 offen offset:0 lds
    s_add_u32 m0, s65, 58240
    s_nop 0
    buffer_load_dwordx4 v9, s[32:35], s64 offen offset:128 lds
    s_waitcnt vmcnt(8)
    s_barrier
    s_and_b32 s58, s58, 7
    s_lshl_b32 s63, s58, 7
    s_add_u32 s63, s63, s60
    s_mul_i32 s64, s58, 196608
    s_add_u32 s64, s64, s61
    s_add_u32 s58, s58, 1
    s_add_u32 m0, s62, 65536
    s_nop 0
    buffer_load_dwordx4 v4, s[28:31], s63 offen lds
    s_add_u32 m0, s62, 66560
    s_nop 0
    buffer_load_dwordx4 v5, s[28:31], s63 offen lds
    s_add_u32 m0, s62, 67584
    s_nop 0
    buffer_load_dwordx4 v6, s[28:31], s63 offen lds
    s_add_u32 m0, s62, 68608
    s_nop 0
    buffer_load_dwordx4 v7, s[28:31], s63 offen lds
    s_add_u32 m0, s65, 81920
    s_nop 0
    buffer_load_dwordx4 v8, s[32:35], s64 offen offset:0 lds
    s_add_u32 m0, s65, 89984
    s_nop 0
    buffer_load_dwordx4 v8, s[32:35], s64 offen offset:128 lds
    s_add_u32 m0, s65, 82944
    s_nop 0
    buffer_load_dwordx4 v9, s[32:35], s64 offen offset:0 lds
    s_add_u32 m0, s65, 91008
    s_nop 0
    buffer_load_dwordx4 v9, s[32:35], s64 offen offset:128 lds
    s_waitcnt vmcnt(8)
    s_barrier
    s_and_b32 s58, s58, 7
    s_lshl_b32 s63, s58, 7
    s_add_u32 s63, s63, s60
    s_mul_i32 s64, s58, 196608
    s_add_u32 s64, s64, s61
    s_add_u32 s58, s58, 1
    s_add_u32 m0, s62, 98304
    s_nop 0
    buffer_load_dwordx4 v4, s[28:31], s63 offen lds
    s_add_u32 m0, s62, 99328
    s_nop 0
    buffer_load_dwordx4 v5, s[28:31], s63 offen lds
    s_add_u32 m0, s62, 100352
    s_nop 0
    buffer_load_dwordx4 v6, s[28:31], s63 offen lds
    s_add_u32 m0, s62, 101376
    s_nop 0
    buffer_load_dwordx4 v7, s[28:31], s63 offen lds
    s_add_u32 m0, s65, 114688
    s_nop 0
    buffer_load_dwordx4 v8, s[32:35], s64 offen offset:0 lds
    s_add_u32 m0, s65, 122752
    s_nop 0
    buffer_load_dwordx4 v8, s[32:35], s64 offen offset:128 lds
    s_add_u32 m0, s65, 115712
    s_nop 0
    buffer_load_dwordx4 v9, s[32:35], s64 offen offset:0 lds
    s_add_u32 m0, s65, 123776
    s_nop 0
    buffer_load_dwordx4 v9, s[32:35], s64 offen offset:128 lds
    s_waitcnt vmcnt(8)
    s_barrier
    s_and_b32 s58, s58, 7
    s_lshl_b32 s63, s58, 7
    s_add_u32 s63, s63, s60
    s_mul_i32 s64, s58, 196608
    s_add_u32 s64, s64, s61
    s_add_u32 s58, s58, 1
    s_add_u32 m0, s62, 0
    s_nop 0
    buffer_load_dwordx4 v4, s[28:31], s63 offen lds
    s_add_u32 m0, s62, 1024
    s_nop 0
    buffer_load_dwordx4 v5, s[28:31], s63 offen lds
    s_add_u32 m0, s62, 2048
    s_nop 0
    buffer_load_dwordx4 v6, s[28:31], s63 offen lds
    s_add_u32 m0, s62, 3072
    s_nop 0
    buffer_load_dwordx4 v7, s[28:31], s63 offen lds
    s_add_u32 m0, s65, 16384
    s_nop 0
    buffer_load_dwordx4 v8, s[32:35], s64 offen offset:0 lds
    s_add_u32 m0, s65, 24448
    s_nop 0
    buffer_load_dwordx4 v8, s[32:35], s64 offen offset:128 lds
    s_add_u32 m0, s65, 17408
    s_nop 0
    buffer_load_dwordx4 v9, s[32:35], s64 offen offset:0 lds
    s_add_u32 m0, s65, 25472
    s_nop 0
    buffer_load_dwordx4 v9, s[32:35], s64 offen offset:128 lds
    s_waitcnt vmcnt(8)
    s_barrier
    s_and_b32 s58, s58, 7
    s_lshl_b32 s63, s58, 7
    s_add_u32 s63, s63, s60
    s_mul_i32 s64, s58, 196608
    s_add_u32 s64, s64, s61
    s_add_u32 s58, s58, 1
    s_add_u32 m0, s62, 32768
    s_nop 0
    buffer_load_dwordx4 v4, s[28:31], s63 offen lds
    s_add_u32 m0, s62, 33792
    s_nop 0
    buffer_load_dwordx4 v5, s[28:31], s63 offen lds
    s_add_u32 m0, s62, 34816
    s_nop 0
    buffer_load_dwordx4 v6, s[28:31], s63 offen lds
    s_add_u32 m0, s62, 35840
    s_nop 0
    buffer_load_dwordx4 v7, s[28:31], s63 offen lds
    s_add_u32 m0, s65, 49152
    s_nop 0
    buffer_load_dwordx4 v8, s[32:35], s64 offen offset:0 lds
    s_add_u32 m0, s65, 57216
    s_nop 0
    buffer_load_dwordx4 v8, s[32:35], s64 offen offset:128 lds
    s_add_u32 m0, s65, 50176
    s_nop 0
    buffer_load_dwordx4 v9, s[32:35], s64 offen offset:0 lds
    s_add_u32 m0, s65, 58240
    s_nop 0
    buffer_load_dwordx4 v9, s[32:35], s64 offen offset:128 lds
    s_waitcnt vmcnt(8)
    s_barrier
    s_and_b32 s58, s58, 7
    s_lshl_b32 s63, s58, 7
    s_add_u32 s63, s63, s60
    s_mul_i32 s64, s58, 196608
    s_add_u32 s64, s64, s61
    s_add_u32 s58, s58, 1
    s_add_u32 m0, s62, 65536
    s_nop 0
    buffer_load_dwordx4 v4, s[28:31], s63 offen lds
    s_add_u32 m0, s62, 66560
    s_nop 0
    buffer_load_dwordx4 v5, s[28:31], s63 offen lds
    s_add_u32 m0, s62, 67584
    s_nop 0
    buffer_load_dwordx4 v6, s[28:31], s63 offen lds
    s_add_u32 m0, s62, 68608
    s_nop 0
    buffer_load_dwordx4 v7, s[28:31], s63 offen lds
    s_add_u32 m0, s65, 81920
    s_nop 0
    buffer_load_dwordx4 v8, s[32:35], s64 offen offset:0 lds
    s_add_u32 m0, s65, 89984
    s_nop 0
    buffer_load_dwordx4 v8, s[32:35], s64 offen offset:128 lds
    s_add_u32 m0, s65, 82944
    s_nop 0
    buffer_load_dwordx4 v9, s[32:35], s64 offen offset:0 lds
    s_add_u32 m0, s65, 91008
    s_nop 0
    buffer_load_dwordx4 v9, s[32:35], s64 offen offset:128 lds
    s_waitcnt vmcnt(8)
    s_barrier
    s_and_b32 s58, s58, 7
    s_lshl_b32 s63, s58, 7
    s_add_u32 s63, s63, s60
    s_mul_i32 s64, s58, 196608
    s_add_u32 s64, s64, s61
    s_add_u32 s58, s58, 1
    s_add_u32 m0, s62, 98304
    s_nop 0
    buffer_load_dwordx4 v4, s[28:31], s63 offen lds
    s_add_u32 m0, s62, 99328
    s_nop 0
    buffer_load_dwordx4 v5, s[28:31], s63 offen lds
    s_add_u32 m0, s62, 100352
    s_nop 0
    buffer_load_dwordx4 v6, s[28:31], s63 offen lds
    s_add_u32 m0, s62, 101376
    s_nop 0
    buffer_load_dwordx4 v7, s[28:31], s63 offen lds
    s_add_u32 m0, s65, 114688
    s_nop 0
    buffer_load_dwordx4 v8, s[32:35], s64 offen offset:0 lds
    s_add_u32 m0, s65, 122752
    s_nop 0
    buffer_load_dwordx4 v8, s[32:35], s64 offen offset:128 lds
    s_add_u32 m0, s65, 115712
    s_nop 0
    buffer_load_dwordx4 v9, s[32:35], s64 offen offset:0 lds
    s_add_u32 m0, s65, 123776
    s_nop 0
    buffer_load_dwordx4 v9, s[32:35], s64 offen offset:128 lds
    s_waitcnt vmcnt(8)
    s_barrier
    s_waitcnt vmcnt(0)
    s_barrier
L_TAIL:
    v_mov_b32 v2, 137472
    ds_read_b64 v[166:167], v2
    s_mov_b32 s28, s26
    s_mov_b32 s29, s27
    s_mov_b32 s30, 0x600000
    s_mov_b32 s31, 0x20000
    s_add_u32 s36, s26, 0xf00000
    s_addc_u32 s37, s27, 0
    s_mov_b32 s38, 0xc0000
    s_mov_b32 s39, 0x20000
    v_and_b32 v3, 3, v1
    v_lshlrev_b32 v3, 2, v3
    v_add_u32 v3, 137296, v3
    s_mov_b32 s62, 0x100000
L_ISSW:
    ds_read_b32 v4, v3 offset:0
    s_waitcnt lgkmcnt(0)
    v_cmp_ne_u32 vcc, 1, v4
    s_sub_u32 s62, s62, 1
    s_cbranch_scc1 L_ISSW_X
    s_cbranch_vccz L_ISSW_X
    s_sleep 2
    s_branch L_ISSW
L_ISSW_X:
ATT:
    s_lshl_b32 s54, s52, 2
    s_and_b32 s55, s53, 3
    s_add_u32 s54, s54, s55
    s_lshr_b32 s55, s53, 2
    s_lshl_b32 s56, s55, 3
    s_add_u32 s56, s56, s3
    s_lshl_b32 s57, s54, 16
    s_lshl_b32 s58, s56, 10
    s_add_u32 s57, s57, s58
    s_lshl_b32 s58, s3, 11
    s_lshl_b32 s59, s54, 17
    s_add_u32 s59, s59, s58
    s_add_u32 s59, s59, 2097152
    s_lshl_b32 s60, s52, 5
    s_lshr_b32 s61, s3, 1
    s_add_u32 s60, s60, s61
    s_lshl_b32 s60, s60, 7
    s_add_u32 s60, s60, 131072
    s_lshl_b32 s61, s55, 9
    v_and_b32 v110, 1, v1
    v_add_u32 v110, 1, v110
    v_lshlrev_b32 v110, 15, v110
    v_bfe_u32 v109, v1, 1, 2
    v_lshl_add_u32 v112, v109, 9, v110
    s_and_b32 s63, s3, 3
    s_lshr_b32 s62, s3, 1
    s_sub_u32 s63, s63, s62
    s_lshl_b32 s63, s63, 7
    v_add_u32 v110, s63, v112
    v_cmp_ne_u32 vcc, 0, v109
    s_nop 0
    s_nop 0
    v_cndmask_b32 v112, v112, v110, vcc
    v_mov_b32 v110, s61
    v_cmp_eq_u32 vcc, 3, v109
    s_nop 0
    s_nop 0
    v_cndmask_b32 v112, v112, v110, vcc
    v_lshrrev_b32 v3, 5, v1
    v_lshlrev_b32 v2, 4, v1
    v_lshlrev_b32 v3, 8, v3
    v_and_b32 v104, 15, v1
    v_lshl_add_u32 v3, v104, 4, v3
    v_add_u32 v3, 1024, v3
    v_mov_b32 v104, v2
    v_mov_b32 v105, v3
    s_mov_b32 s40, 0x0000ffff
    s_mov_b32 s41, 0x0000ffff
    v_and_b32 v106, 27, v1
    v_cmp_eq_u32 vcc, 16, v106
    v_mov_b32 v106, 0x3f803f80
    s_nop 0
    v_cndmask_b32 v106, 0, v106, vcc
    v_mov_b32 v88, v106
    v_mov_b32 v89, v106
    v_mov_b32 v90, v106
    v_mov_b32 v91, v106
    v_mov_b32 v92, v106
    v_mov_b32 v93, v106
    v_mov_b32 v94, v106
    v_mov_b32 v95, v106
    v_mov_b32 v96, v106
    v_mov_b32 v97, v106
    v_mov_b32 v98, v106
    v_mov_b32 v99, v106
    v_mov_b32 v100, v106
    v_mov_b32 v101, v106
    v_mov_b32 v102, v106
    v_mov_b32 v103, v106
    v_mov_b32 v64, 0
    v_mov_b32 v65, 0
    v_mov_b32 v66, 0
    v_mov_b32 v67, 0
    v_mov_b32 v68, 0
    v_mov_b32 v69, 0
    v_mov_b32 v70, 0
    v_mov_b32 v71, 0
    v_mov_b32 v72, 0
    v_mov_b32 v73, 0
    v_mov_b32 v74, 0
    v_mov_b32 v75, 0
    v_mov_b32 v76, 0
    v_mov_b32 v77, 0
    v_mov_b32 v78, 0
    v_mov_b32 v79, 0
    v_mov_b32 v60, 0
    v_mov_b32 v61, 0
    v_mov_b32 v62, 0
    v_mov_b32 v63, 0
    s_lshl_b32 s63, s3, 2
    s_add_u32 s63, s63, 137312
    v_mov_b32 v108, s63
    v_mov_b32 v109, 1
    v_and_b32 v107, 7, v1
    v_lshlrev_b32 v107, 2, v107
    v_add_u32 v107, 137312, v107
    v_and_b32 v111, 3, v1
    v_lshlrev_b32 v111, 2, v111
    v_add_u32 v111, 137280, v111
    s_cmp_lt_u32 s3, 4
    s_cselect_b32 s63, 0, 60
    s_or_b32 exec_lo, s63, 0x43
    s_mov_b32 exec_hi, 0
    s_mov_b32 s62, 0x40000
A_POLL:
    buffer_load_dwordx2 v[24:25], v112, s[36:39], s60 offen sc1
    s_waitcnt vmcnt(0)
    v_xor_b32 v24, v24, v166
    v_xor_b32 v25, v25, v167
    v_or_b32 v24, v24, v25
    v_cmp_ne_u32 vcc, 0, v24
    s_sub_u32 s62, s62, 1
    s_cbranch_scc1 A_POLL_X
    s_and_b32 s61, vcc_lo, 195
    s_cbranch_scc0 A_POLL_X
    s_sleep 2
    s_branch A_POLL
A_POLL_X:
    s_mov_b32 s61, vcc_lo
    s_mov_b64 exec, -1
    s_mov_b32 m0, s58
    s_setprio 2
    buffer_load_dwordx4 v2, s[28:31], s59 offen sc1 lds
    buffer_load_dwordx4 v[4:7], v2, s[28:31], s57 offen sc1
    buffer_load_dwordx4 v2, s[28:31], s59 offen offset:1024 sc1 lds
    s_waitcnt vmcnt(0)
    ds_write_b32 v108, v109
    s_mov_b32 s62, 0x100000
A_C0:
    ds_read_b32 v110, v107 offset:0
    s_waitcnt lgkmcnt(0)
    v_cmp_ne_u32 vcc, 1, v110
    s_sub_u32 s62, s62, 1
    s_cbranch_scc1 A_C0_X
    s_cbranch_vccz A_C0_X
    s_sleep 1
    s_branch A_C0
A_C0_X:
    s_cmp_lt_u32 s3, 4
    s_cbranch_scc1 A_C12
    s_cmp_eq_u32 s61, 0
    s_cbranch_scc1 A_POLL2_X
    s_mov_b32 s62, 0x40000
A_POLL2:
    buffer_load_dwordx2 v[24:25], v112, s[36:39], s60 offen sc1
    s_waitcnt vmcnt(0)
    v_xor_b32 v24, v24, v166
    v_xor_b32 v25, v25, v167
    v_or_b32 v24, v24, v25
    v_cmp_ne_u32 vcc, 0, v24
    s_sub_u32 s62, s62, 1
    s_cbranch_scc1 A_POLL2_X
    s_cbranch_vccz A_POLL2_X
    s_sleep 2
    s_branch A_POLL2
A_POLL2_X:
    s_sub_u32 s59, s59, s58
    s_and_b32 s58, s3, 3
    s_lshl_b32 s58, s58, 12
    s_add_u32 s59, s59, s58
    s_add_u32 m0, s58, 16384
    s_add_u32 s59, s59, 16384
    buffer_load_dwordx4 v2, s[28:31], s59 offen offset:0 sc1 lds
    buffer_load_dwordx4 v2, s[28:31], s59 offen offset:1024 sc1 lds
    buffer_load_dwordx4 v2, s[28:31], s59 offen offset:2048 sc1 lds
    buffer_load_dwordx4 v2, s[28:31], s59 offen offset:3072 sc1 lds
    s_add_u32 m0, s58, 32768
    s_add_u32 s59, s59, 16384
    buffer_load_dwordx4 v2, s[28:31], s59 offen offset:0 sc1 lds
    buffer_load_dwordx4 v2, s[28:31], s59 offen offset:1024 sc1 lds
    buffer_load_dwordx4 v2, s[28:31], s59 offen offset:2048 sc1 lds
    buffer_load_dwordx4 v2, s[28:31], s59 offen offset:3072 sc1 lds
    s_waitcnt vmcnt(0)
    ds_write_b32 v108, v109 offset:80
A_C12:
    s_add_u32 s32, s26, 0xa00000
    s_addc_u32 s33, s27, 0
    s_mov_b32 s34, 0x200000
    s_mov_b32 s35, 0x20000
    ds_read_b128 v[80:83], v104 offset:0
    ds_read_b128 v[84:87], v104 offset:2048
    s_mov_b64 exec, s[40:41]
    ds_read_b128 v[88:91], v105 offset:0
    ds_read_b128 v[92:95], v105 offset:512
    s_mov_b64 exec, -1
    s_waitcnt lgkmcnt(3)
    v_mfma_f32_32x32x16_bf16 v[24:39], v[80:83], v[4:7], 0
    s_nop 11
    v_max3_f32 v24, v24, v25, v26
    v_max3_f32 v24, v24, v27, v28
    v_max3_f32 v24, v24, v29, v30
    v_max3_f32 v24, v24, v31, v32
    v_max3_f32 v24, v24, v33, v34
    v_max3_f32 v24, v24, v35, v36
    v_max3_f32 v24, v24, v37, v38
    v_max_f32 v24, v24, v39
    v_mov_b32 v25, v24
    s_nop 1
    v_permlane32_swap_b32 v24, v25
    v_max_f32 v24, v24, v25
    v_sub_f32 v8, 0, v24
    v_mov_b32 v9, v8
    v_mov_b32 v10, v8
    v_mov_b32 v11, v8
    v_mov_b32 v12, v8
    v_mov_b32 v13, v8
    v_mov_b32 v14, v8
    v_mov_b32 v15, v8
    v_mov_b32 v16, v8
    v_mov_b32 v17, v8
    v_mov_b32 v18, v8
    v_mov_b32 v19, v8
    v_mov_b32 v20, v8
    v_mov_b32 v21, v8
    v_mov_b32 v22, v8
    v_mov_b32 v23, v8
    s_nop 1
    v_mfma_f32_32x32x16_bf16 v[24:39], v[80:83], v[4:7], v[8:23]
    s_mov_b32 s43, 16384
    s_mov_b32 s44, 8
    s_mov_b32 s45, 340
    s_nop 7
.p2align 6
A_LOOP:
    s_nop 0
    v_exp_f32 v24, v24
    v_exp_f32 v25, v25
    v_mfma_f32_32x32x16_bf16 v[64:79], v[100:103], v[60:63], v[64:79]
    v_exp_f32 v26, v26
    v_exp_f32 v27, v27
    v_exp_f32 v28, v28
    v_exp_f32 v29, v29
    v_exp_f32 v30, v30
    v_exp_f32 v31, v31
    s_waitcnt lgkmcnt(2)
    v_mfma_f32_32x32x16_bf16 v[40:55], v[84:87], v[4:7], v[8:23]
    ds_read_b128 v[80:83], v104 offset:4096
    v_cvt_pk_bf16_f32 v56, v24, v25
    v_cvt_pk_bf16_f32 v57, v26, v27
    v_cvt_pk_bf16_f32 v58, v28, v29
    v_cvt_pk_bf16_f32 v59, v30, v31
    v_exp_f32 v32, v32
    v_exp_f32 v33, v33
    v_exp_f32 v34, v34
    v_exp_f32 v35, v35
    s_waitcnt lgkmcnt(1)
    v_mfma_f32_32x32x16_bf16 v[64:79], v[88:91], v[56:59], v[64:79]
    s_mov_b64 exec, s[40:41]
    ds_read_b128 v[96:99], v105 offset:2048
    ds_read_b128 v[100:103], v105 offset:2560
    s_mov_b64 exec, -1
    v_exp_f32 v36, v36
    v_exp_f32 v37, v37
    v_exp_f32 v38, v38
    v_exp_f32 v39, v39
    v_cvt_pk_bf16_f32 v60, v32, v33
    v_cvt_pk_bf16_f32 v61, v34, v35
    v_cvt_pk_bf16_f32 v62, v36, v37
    v_cvt_pk_bf16_f32 v63, v38, v39
    v_exp_f32 v40, v40
    v_exp_f32 v41, v41
    v_mfma_f32_32x32x16_bf16 v[64:79], v[92:95], v[60:63], v[64:79]
    v_exp_f32 v42, v42
    v_exp_f32 v43, v43
    v_exp_f32 v44, v44
    v_exp_f32 v45, v45
    v_exp_f32 v46, v46
    v_exp_f32 v47, v47
    s_waitcnt lgkmcnt(2)
    v_mfma_f32_32x32x16_bf16 v[24:39], v[80:83], v[4:7], v[8:23]
    ds_read_b128 v[84:87], v104 offset:6144
    v_cvt_pk_bf16_f32 v56, v40, v41
    v_cvt_pk_bf16_f32 v57, v42, v43
    v_cvt_pk_bf16_f32 v58, v44, v45
    v_cvt_pk_bf16_f32 v59, v46, v47
    v_exp_f32 v48, v48
    v_exp_f32 v49, v49
    v_exp_f32 v50, v50
    v_exp_f32 v51, v51
    s_waitcnt lgkmcnt(1)
    v_mfma_f32_32x32x16_bf16 v[64:79], v[96:99], v[56:59], v[64:79]
    s_mov_b64 exec, s[40:41]
    ds_read_b128 v[88:91], v105 offset:4096
    ds_read_b128 v[92:95], v105 offset:4608
    s_mov_b64 exec, -1
    v_exp_f32 v52, v52
    v_exp_f32 v53, v53
    v_exp_f32 v54, v54
    v_exp_f32 v55, v55
    v_cvt_pk_bf16_f32 v60, v48, v49
    v_cvt_pk_bf16_f32 v61, v50, v51
    v_cvt_pk_bf16_f32 v62, v52, v53
    v_cvt_pk_bf16_f32 v63, v54, v55
    v_exp_f32 v24, v24
    v_exp_f32 v25, v25
    v_mfma_f32_32x32x16_bf16 v[64:79], v[100:103], v[60:63], v[64:79]
    v_exp_f32 v26, v26
    v_exp_f32 v27, v27
    v_exp_f32 v28, v28
    v_exp_f32 v29, v29
    v_exp_f32 v30, v30
    v_exp_f32 v31, v31
    s_waitcnt lgkmcnt(2)
    v_mfma_f32_32x32x16_bf16 v[40:55], v[84:87], v[4:7], v[8:23]
    ds_read_b128 v[80:83], v104 offset:8192
    v_cvt_pk_bf16_f32 v56, v24, v25
    v_cvt_pk_bf16_f32 v57, v26, v27
    v_cvt_pk_bf16_f32 v58, v28, v29
    v_cvt_pk_bf16_f32 v59, v30, v31
    v_exp_f32 v32, v32
    v_exp_f32 v33, v33
    v_exp_f32 v34, v34
    v_exp_f32 v35, v35
    s_waitcnt lgkmcnt(1)
    v_mfma_f32_32x32x16_bf16 v[64:79], v[88:91], v[56:59], v[64:79]
    s_mov_b64 exec, s[40:41]
    ds_read_b128 v[96:99], v105 offset:6144
    ds_read_b128 v[100:103], v105 offset:6656
    s_mov_b64 exec, -1
    v_exp_f32 v36, v36
    v_exp_f32 v37, v37
    v_exp_f32 v38, v38
    v_exp_f32 v39, v39
    v_cvt_pk_bf16_f32 v60, v32, v33
    v_cvt_pk_bf16_f32 v61, v34, v35
    v_cvt_pk_bf16_f32 v62, v36, v37
    v_cvt_pk_bf16_f32 v63, v38, v39
    v_exp_f32 v40, v40
    v_exp_f32 v41, v41
    v_mfma_f32_32x32x16_bf16 v[64:79], v[92:95], v[60:63], v[64:79]
    v_exp_f32 v42, v42
    v_exp_f32 v43, v43
    v_exp_f32 v44, v44
    v_exp_f32 v45, v45
    v_exp_f32 v46, v46
    v_exp_f32 v47, v47
    s_waitcnt lgkmcnt(2)
    v_mfma_f32_32x32x16_bf16 v[24:39], v[80:83], v[4:7], v[8:23]
    ds_read_b128 v[84:87], v104 offset:10240
    v_cvt_pk_bf16_f32 v56, v40, v41
    v_cvt_pk_bf16_f32 v57, v42, v43
    v_cvt_pk_bf16_f32 v58, v44, v45
    v_cvt_pk_bf16_f32 v59, v46, v47
    v_exp_f32 v48, v48
    v_exp_f32 v49, v49
    v_exp_f32 v50, v50
    v_exp_f32 v51, v51
    s_waitcnt lgkmcnt(1)
    v_mfma_f32_32x32x16_bf16 v[64:79], v[96:99], v[56:59], v[64:79]
    s_mov_b64 exec, s[40:41]
    ds_read_b128 v[88:91], v105 offset:8192
    ds_read_b128 v[92:95], v105 offset:8704
    s_mov_b64 exec, -1
    v_exp_f32 v52, v52
    v_exp_f32 v53, v53
    v_exp_f32 v54, v54
    v_exp_f32 v55, v55
    v_cvt_pk_bf16_f32 v60, v48, v49
    v_cvt_pk_bf16_f32 v61, v50, v51
    v_cvt_pk_bf16_f32 v62, v52, v53
    v_cvt_pk_bf16_f32 v63, v54, v55
    v_exp_f32 v24, v24
    v_exp_f32 v25, v25
    v_mfma_f32_32x32x16_bf16 v[64:79], v[100:103], v[60:63], v[64:79]
    v_exp_f32 v26, v26
    v_exp_f32 v27, v27
    v_exp_f32 v28, v28
    v_exp_f32 v29, v29
    v_exp_f32 v30, v30
    v_exp_f32 v31, v31
    s_waitcnt lgkmcnt(2)
    v_mfma_f32_32x32x16_bf16 v[40:55], v[84:87], v[4:7], v[8:23]
    ds_read_b128 v[80:83], v104 offset:12288
    v_cvt_pk_bf16_f32 v56, v24, v25
    v_cvt_pk_bf16_f32 v57, v26, v27
    v_cvt_pk_bf16_f32 v58, v28, v29
    v_cvt_pk_bf16_f32 v59, v30, v31
    v_exp_f32 v32, v32
    v_exp_f32 v33, v33
    v_exp_f32 v34, v34
    v_exp_f32 v35, v35
    s_waitcnt lgkmcnt(1)
    v_mfma_f32_32x32x16_bf16 v[64:79], v[88:91], v[56:59], v[64:79]
    s_mov_b64 exec, s[40:41]
    ds_read_b128 v[96:99], v105 offset:10240
    ds_read_b128 v[100:103], v105 offset:10752
    s_mov_b64 exec, -1
    v_exp_f32 v36, v36
    v_exp_f32 v37, v37
    v_exp_f32 v38, v38
    v_exp_f32 v39, v39
    v_cvt_pk_bf16_f32 v60, v32, v33
    v_cvt_pk_bf16_f32 v61, v34, v35
    v_cvt_pk_bf16_f32 v62, v36, v37
    v_cvt_pk_bf16_f32 v63, v38, v39
    v_exp_f32 v40, v40
    v_exp_f32 v41, v41
    v_mfma_f32_32x32x16_bf16 v[64:79], v[92:95], v[60:63], v[64:79]
    v_exp_f32 v42, v42
    v_exp_f32 v43, v43
    v_exp_f32 v44, v44
    v_exp_f32 v45, v45
    v_exp_f32 v46, v46
    v_exp_f32 v47, v47
    s_waitcnt lgkmcnt(2)
    v_mfma_f32_32x32x16_bf16 v[24:39], v[80:83], v[4:7], v[8:23]
    ds_read_b128 v[84:87], v104 offset:14336
    v_cvt_pk_bf16_f32 v56, v40, v41
    v_cvt_pk_bf16_f32 v57, v42, v43
    v_cvt_pk_bf16_f32 v58, v44, v45
    v_cvt_pk_bf16_f32 v59, v46, v47
    v_exp_f32 v48, v48
    v_exp_f32 v49, v49
    v_exp_f32 v50, v50
    v_exp_f32 v51, v51
    s_waitcnt lgkmcnt(1)
    v_mfma_f32_32x32x16_bf16 v[64:79], v[96:99], v[56:59], v[64:79]
    s_mov_b64 exec, s[40:41]
    ds_read_b128 v[88:91], v105 offset:12288
    ds_read_b128 v[92:95], v105 offset:12800
    s_mov_b64 exec, -1
    v_exp_f32 v52, v52
    v_exp_f32 v53, v53
    v_exp_f32 v54, v54
    v_exp_f32 v55, v55
    v_cvt_pk_bf16_f32 v60, v48, v49
    v_cvt_pk_bf16_f32 v61, v50, v51
    v_cvt_pk_bf16_f32 v62, v52, v53
    v_cvt_pk_bf16_f32 v63, v54, v55
    v_exp_f32 v24, v24
    v_exp_f32 v25, v25
    v_mfma_f32_32x32x16_bf16 v[64:79], v[100:103], v[60:63], v[64:79]
    v_exp_f32 v26, v26
    v_exp_f32 v27, v27
    v_exp_f32 v28, v28
    v_exp_f32 v29, v29
    v_exp_f32 v30, v30
    v_exp_f32 v31, v31
    s_waitcnt lgkmcnt(2)
    v_mfma_f32_32x32x16_bf16 v[40:55], v[84:87], v[4:7], v[8:23]
    s_bitcmp1_b32 s45, s44
    v_add_u32 v104, s43, v2
    s_cbranch_scc1 A_EVENT
A_BACK:
    ds_read_b128 v[80:83], v104 offset:0
    v_cvt_pk_bf16_f32 v56, v24, v25
    v_cvt_pk_bf16_f32 v57, v26, v27
    v_cvt_pk_bf16_f32 v58, v28, v29
    v_cvt_pk_bf16_f32 v59, v30, v31
    v_exp_f32 v32, v32
    v_exp_f32 v33, v33
    v_exp_f32 v34, v34
    v_exp_f32 v35, v35
    s_waitcnt lgkmcnt(1)
    v_mfma_f32_32x32x16_bf16 v[64:79], v[88:91], v[56:59], v[64:79]
    s_mov_b64 exec, s[40:41]
    ds_read_b128 v[96:99], v105 offset:14336
    ds_read_b128 v[100:103], v105 offset:14848
    s_mov_b64 exec, -1
    v_exp_f32 v36, v36
    v_exp_f32 v37, v37
    v_exp_f32 v38, v38
    v_exp_f32 v39, v39
    v_cvt_pk_bf16_f32 v60, v32, v33
    v_cvt_pk_bf16_f32 v61, v34, v35
    v_cvt_pk_bf16_f32 v62, v36, v37
    v_cvt_pk_bf16_f32 v63, v38, v39
    v_exp_f32 v40, v40
    v_exp_f32 v41, v41
    v_mfma_f32_32x32x16_bf16 v[64:79], v[92:95], v[60:63], v[64:79]
    v_exp_f32 v42, v42
    v_exp_f32 v43, v43
    v_exp_f32 v44, v44
    v_exp_f32 v45, v45
    v_exp_f32 v46, v46
    v_exp_f32 v47, v47
    s_waitcnt lgkmcnt(2)
    v_mfma_f32_32x32x16_bf16 v[24:39], v[80:83], v[4:7], v[8:23]
    ds_read_b128 v[84:87], v104 offset:2048
    v_cvt_pk_bf16_f32 v56, v40, v41
    v_cvt_pk_bf16_f32 v57, v42, v43
    v_cvt_pk_bf16_f32 v58, v44, v45
    v_cvt_pk_bf16_f32 v59, v46, v47
    v_exp_f32 v48, v48
    v_exp_f32 v49, v49
    v_exp_f32 v50, v50
    v_exp_f32 v51, v51
    s_waitcnt lgkmcnt(1)
    v_mfma_f32_32x32x16_bf16 v[64:79], v[96:99], v[56:59], v[64:79]
    v_add_u32 v105, s43, v3
    s_add_u32 s43, s43, 16384
    s_and_b32 s43, s43, 0x1ffff
    s_mov_b64 exec, s[40:41]
    ds_read_b128 v[88:91], v105 offset:0
    ds_read_b128 v[92:95], v105 offset:512
    s_mov_b64 exec, -1
    v_exp_f32 v52, v52
    v_exp_f32 v53, v53
    v_exp_f32 v54, v54
    v_exp_f32 v55, v55
    s_sub_u32 s44, s44, 1
    s_cmp_lg_u32 s44, 0
    v_cvt_pk_bf16_f32 v60, v48, v49
    v_cvt_pk_bf16_f32 v61, v50, v51
    v_cvt_pk_bf16_f32 v62, v52, v53
    v_cvt_pk_bf16_f32 v63, v54, v55
    s_cbranch_scc1 A_LOOP
    s_nop 1
    v_mfma_f32_32x32x16_bf16 v[64:79], v[100:103], v[60:63], v[64:79]
    s_waitcnt lgkmcnt(0)
    v_mov_b32 v26, 0x4e800000
    v_mov_b32 v27, 0x7b800000
    s_lshr_b32 s59, s56, 1
    s_lshl_b32 s59, s59, 2
    s_and_b32 s60, s53, 3
    s_add_u32 s59, s59, s60
    s_lshl_b32 s59, s59, 3
    s_add_u32 s59, s59, s52
    s_lshl_b32 s59, s59, 1
    s_and_b32 s60, s3, 1
    s_add_u32 s59, s59, s60
    s_lshl_b32 s59, s59, 7
    s_add_u32 s59, s59, 524288
    v_rcp_f32 v24, v72
    v_max3_f32 v25, |v64|, |v65|, |v66|
    v_max3_f32 v25, v25, |v67|, |v68|
    v_max3_f32 v25, v25, |v69|, |v70|
    v_max_f32 v25, v25, |v71|
    v_cmp_nle_f32 vcc, v72, v26
    v_cmp_nle_f32 s[46:47], v25, v27
    s_nop 0
    s_or_b64 vcc, vcc, s[46:47]
    ds_write_b32 v108, v109 offset:32
    s_cbranch_vccnz A_SLOW
A_OUT:
    v_mul_f32 v64, v64, v24
    v_mul_f32 v65, v65, v24
    v_mul_f32 v66, v66, v24
    v_mul_f32 v67, v67, v24
    v_mul_f32 v68, v68, v24
    v_mul_f32 v69, v69, v24
    v_mul_f32 v70, v70, v24
    v_mul_f32 v71, v71, v24
    v_cvt_pk_bf16_f32 v56, v64, v65
    v_cvt_pk_bf16_f32 v57, v66, v67
    v_cvt_pk_bf16_f32 v58, v68, v69
    v_cvt_pk_bf16_f32 v59, v70, v71
    buffer_store_dwordx4 v[56:59], v2, s[32:35], s57 offen sc1
    v_lshlrev_b32 v110, 20, v1
    s_waitcnt vmcnt(0)
    buffer_store_dwordx2 v[166:167], v110, s[36:39], s59 offen sc1
    s_cmp_lt_u32 s3, 4
    s_cbranch_scc1 P3_LOAD
END:
    s_endpgm
A_EVENT:
    s_cmp_eq_u32 s44, 8
    s_cbranch_scc0 A_EV1
    s_mov_b32 s62, 0x100000
A_KVW1:
    ds_read_b32 v110, v111 offset:128
    s_waitcnt lgkmcnt(0)
    v_cmp_ne_u32 vcc, 1, v110
    s_sub_u32 s62, s62, 1
    s_cbranch_scc1 A_KVW1_X
    s_cbranch_vccz A_KVW1_X
    s_sleep 2
    s_branch A_KVW1
A_KVW1_X:
    s_branch A_BACK
A_EV1:
    s_cmp_eq_u32 s44, 6
    s_cbranch_scc0 A_EV2
    s_mov_b32 s62, 0x100000
A_KVW2:
    ds_read_b32 v110, v111 offset:0
    s_waitcnt lgkmcnt(0)
    v_cmp_ne_u32 vcc, 1, v110
    s_sub_u32 s62, s62, 1
    s_cbranch_scc1 A_KVW2_X
    s_cbranch_vccz A_KVW2_X
    s_sleep 2
    s_branch A_KVW2
A_KVW2_X:
    s_branch A_BACK
A_EV2:
    s_setprio 1
    ds_write_b32 v108, v109 offset:64
    s_cmp_eq_u32 s44, 4
    s_cbranch_scc1 A_BACK
    s_setprio 0
    s_branch A_BACK
A_SLOW:
    s_lshl_b32 s63, s54, 17
    s_add_u32 s63, s63, 2097152
    s_mov_b32 s61, s63
    v_mov_b32 v56, 0xff800000
    s_mov_b32 s44, 64
A_SLOWL:
    buffer_load_dwordx4 v[80:83], v2, s[28:31], s61 offen sc1
    s_add_u32 s61, s61, 2048
    s_waitcnt vmcnt(0)
    v_mfma_f32_32x32x16_bf16 v[24:39], v[80:83], v[4:7], 0
    s_nop 15
    v_max3_f32 v56, v56, v24, v25
    v_max3_f32 v56, v56, v26, v27
    v_max3_f32 v56, v56, v28, v29
    v_max3_f32 v56, v56, v30, v31
    v_max3_f32 v56, v56, v32, v33
    v_max3_f32 v56, v56, v34, v35
    v_max3_f32 v56, v56, v36, v37
    v_max3_f32 v56, v56, v38, v39
    s_sub_u32 s44, s44, 1
    s_cmp_lg_u32 s44, 0
    s_cbranch_scc1 A_SLOWL
    v_mov_b32 v57, v56
    s_nop 1
    v_permlane32_swap_b32 v56, v57
    v_max_f32 v56, v56, v57
    v_sub_f32 v8, 0, v56
    v_mov_b32 v9, v8
    v_mov_b32 v10, v8
    v_mov_b32 v11, v8
    v_mov_b32 v12, v8
    v_mov_b32 v13, v8
    v_mov_b32 v14, v8
    v_mov_b32 v15, v8
    v_mov_b32 v16, v8
    v_mov_b32 v17, v8
    v_mov_b32 v18, v8
    v_mov_b32 v19, v8
    v_mov_b32 v20, v8
    v_mov_b32 v21, v8
    v_mov_b32 v22, v8
    v_mov_b32 v23, v8
    v_mov_b32 v64, 0
    v_mov_b32 v65, 0
    v_mov_b32 v66, 0
    v_mov_b32 v67, 0
    v_mov_b32 v68, 0
    v_mov_b32 v69, 0
    v_mov_b32 v70, 0
    v_mov_b32 v71, 0
    v_mov_b32 v72, 0
    v_mov_b32 v73, 0
    v_mov_b32 v74, 0
    v_mov_b32 v75, 0
    v_mov_b32 v76, 0
    v_mov_b32 v77, 0
    v_mov_b32 v78, 0
    v_mov_b32 v79, 0
    s_mov_b32 s44, 64
A_SLOW2:
    buffer_load_dwordx4 v[80:83], v2, s[28:31], s63 offen sc1
    s_mov_b64 exec, s[40:41]
    buffer_load_dwordx4 v[88:91], v3, s[28:31], s63 offen sc1
    buffer_load_dwordx4 v[92:95], v3, s[28:31], s63 offen offset:512 sc1
    s_mov_b64 exec, -1
    s_add_u32 s63, s63, 2048
    s_waitcnt vmcnt(0)
    v_mfma_f32_32x32x16_bf16 v[24:39], v[80:83], v[4:7], v[8:23]
    s_nop 15
    v_exp_f32 v24, v24
    v_exp_f32 v25, v25
    v_exp_f32 v26, v26
    v_exp_f32 v27, v27
    v_exp_f32 v28, v28
    v_exp_f32 v29, v29
    v_exp_f32 v30, v30
    v_exp_f32 v31, v31
    v_exp_f32 v32, v32
    v_exp_f32 v33, v33
    v_exp_f32 v34, v34
    v_exp_f32 v35, v35
    v_exp_f32 v36, v36
    v_exp_f32 v37, v37
    v_exp_f32 v38, v38
    v_exp_f32 v39, v39
    v_cvt_pk_bf16_f32 v56, v24, v25
    v_cvt_pk_bf16_f32 v57, v26, v27
    v_cvt_pk_bf16_f32 v58, v28, v29
    v_cvt_pk_bf16_f32 v59, v30, v31
    v_cvt_pk_bf16_f32 v60, v32, v33
    v_cvt_pk_bf16_f32 v61, v34, v35
    v_cvt_pk_bf16_f32 v62, v36, v37
    v_cvt_pk_bf16_f32 v63, v38, v39
    v_mfma_f32_32x32x16_bf16 v[64:79], v[88:91], v[56:59], v[64:79]
    s_nop 0
    v_mfma_f32_32x32x16_bf16 v[64:79], v[92:95], v[60:63], v[64:79]
    s_sub_u32 s44, s44, 1
    s_cmp_lg_u32 s44, 0
    s_nop 7
    s_cbranch_scc1 A_SLOW2
    s_nop 15
    v_rcp_f32 v24, v72
    s_nop 1
    s_branch A_OUT
P3_LOAD:
    v_lshrrev_b32 v6, 3, v1
    v_mul_u32_u24 v6, 1024, v6
    v_bfe_u32 v7, v1, 4, 1
    v_lshlrev_b32 v7, 2, v7
    v_xor_b32 v7, v7, v1
    v_and_b32 v7, 7, v7
    v_lshl_add_u32 v4, v7, 4, v6
    v_add_u32 v5, 8192, v4
    s_lshl_b32 s54, s52, 2
    s_lshr_b32 s55, s53, 3
    s_add_u32 s54, s54, s55
    s_and_b32 s56, s53, 7
    s_lshl_b32 s57, s55, 1
    s_add_u32 s57, s57, s56
    s_lshl_b32 s58, s3, 14
    s_lshl_b32 s59, s56, 7
    s_add_u32 s58, s58, s59
    s_lshl_b32 s59, s3, 16
    s_lshl_b32 s60, s54, 11
    s_add_u32 s59, s59, s60
    s_lshl_b32 s60, s3, 11
    s_mov_b32 s28, s8
    s_mov_b32 s29, s9
    s_mov_b32 s30, 0x80000
    s_mov_b32 s31, 0x20000
    s_lshl_b32 s61, s54, 2
    s_add_u32 s61, s61, s3
    s_lshl_b32 s61, s61, 11
    s_add_u32 s61, s61, 524288
    s_mov_b32 s62, 0x100000
P3_PAST:
    ds_read_b32 v110, v107 offset:64
    s_waitcnt lgkmcnt(0)
    v_cmp_ne_u32 vcc, 1, v110
    s_sub_u32 s62, s62, 1
    s_cbranch_scc1 P3_PAST_X
    s_cbranch_vccz P3_PAST_X
    s_sleep 2
    s_branch P3_PAST
P3_PAST_X:
    s_add_u32 s63, s57, 0
    s_and_b32 s63, s63, 7
    s_lshl_b32 s63, s63, 16
    s_add_u32 m0, s60, 0
    s_add_u32 s63, s63, s58
    buffer_load_dwordx4 v4, s[28:31], s63 offen lds
    s_add_u32 m0, s60, 1024
    s_nop 0
    buffer_load_dwordx4 v5, s[28:31], s63 offen lds
    s_add_u32 s63, s57, 1
    s_and_b32 s63, s63, 7
    s_lshl_b32 s63, s63, 16
    s_add_u32 m0, s60, 8192
    s_add_u32 s63, s63, s58
    buffer_load_dwordx4 v4, s[28:31], s63 offen lds
    s_add_u32 m0, s60, 9216
    s_nop 0
    buffer_load_dwordx4 v5, s[28:31], s63 offen lds
    s_add_u32 s63, s57, 2
    s_and_b32 s63, s63, 7
    s_lshl_b32 s63, s63, 16
    s_add_u32 m0, s60, 16384
    s_add_u32 s63, s63, s58
    buffer_load_dwordx4 v4, s[28:31], s63 offen lds
    s_add_u32 m0, s60, 17408
    s_nop 0
    buffer_load_dwordx4 v5, s[28:31], s63 offen lds
    s_add_u32 s63, s57, 3
    s_and_b32 s63, s63, 7
    s_lshl_b32 s63, s63, 16
    s_add_u32 m0, s60, 24576
    s_add_u32 s63, s63, s58
    buffer_load_dwordx4 v4, s[28:31], s63 offen lds
    s_add_u32 m0, s60, 25600
    s_nop 0
    buffer_load_dwordx4 v5, s[28:31], s63 offen lds
    s_add_u32 s63, s57, 4
    s_and_b32 s63, s63, 7
    s_lshl_b32 s63, s63, 16
    s_add_u32 m0, s60, 32768
    s_add_u32 s63, s63, s58
    buffer_load_dwordx4 v4, s[28:31], s63 offen lds
    s_add_u32 m0, s60, 33792
    s_nop 0
    buffer_load_dwordx4 v5, s[28:31], s63 offen lds
    s_add_u32 s63, s57, 5
    s_and_b32 s63, s63, 7
    s_lshl_b32 s63, s63, 16
    s_add_u32 m0, s60, 40960
    s_add_u32 s63, s63, s58
    buffer_load_dwordx4 v4, s[28:31], s63 offen lds
    s_add_u32 m0, s60, 41984
    s_nop 0
    buffer_load_dwordx4 v5, s[28:31], s63 offen lds
    s_add_u32 s63, s57, 6
    s_and_b32 s63, s63, 7
    s_lshl_b32 s63, s63, 16
    s_add_u32 m0, s60, 49152
    s_add_u32 s63, s63, s58
    buffer_load_dwordx4 v4, s[28:31], s63 offen lds
    s_add_u32 m0, s60, 50176
    s_nop 0
    buffer_load_dwordx4 v5, s[28:31], s63 offen lds
    s_add_u32 s63, s57, 7
    s_and_b32 s63, s63, 7
    s_lshl_b32 s63, s63, 16
    s_add_u32 m0, s60, 57344
    s_add_u32 s63, s63, s58
    buffer_load_dwordx4 v4, s[28:31], s63 offen lds
    s_add_u32 m0, s60, 58368
    s_nop 0
    buffer_load_dwordx4 v5, s[28:31], s63 offen lds
    s_mov_b32 s62, 0x100000
P3_DONE:
    ds_read_b32 v110, v107 offset:32
    s_waitcnt lgkmcnt(0)
    v_cmp_ne_u32 vcc, 1, v110
    s_sub_u32 s62, s62, 1
    s_cbranch_scc1 P3_DONE_X
    s_cbranch_vccz P3_DONE_X
    s_sleep 2
    s_branch P3_DONE
P3_DONE_X:
    s_mov_b32 s62, 0x100000
P3_M2:
    ds_read_b32 v110, v111 offset:160
    s_waitcnt lgkmcnt(0)
    v_cmp_ne_u32 vcc, 1, v110
    s_sub_u32 s62, s62, 1
    s_cbranch_scc1 P3_M2_X
    s_cbranch_vccz P3_M2_X
    s_sleep 2
    s_branch P3_M2
P3_M2_X:
    v_and_b32 v6, 15, v1
    v_lshlrev_b32 v6, 7, v6
    s_mov_b32 s62, 0x40000
P3_POLL:
    buffer_load_dwordx2 v[8:9], v6, s[36:39], s61 offen sc1
    s_waitcnt vmcnt(0)
    v_xor_b32 v8, v8, v166
    v_xor_b32 v9, v9, v167
    v_or_b32 v8, v8, v9
    v_cmp_ne_u32 vcc, 0, v8
    s_sub_u32 s62, s62, 1
    s_cbranch_scc1 P3_POLL_X
    s_cbranch_vccz P3_POLL_X
    s_sleep 2
    s_branch P3_POLL
P3_POLL_X:
    s_add_u32 s63, s57, 0
    s_and_b32 s63, s63, 7
    s_lshl_b32 s63, s63, 18
    s_add_u32 m0, s60, 65536
    s_add_u32 s63, s63, s59
    buffer_load_dwordx4 v2, s[32:35], s63 offen sc1 lds
    buffer_load_dwordx4 v2, s[32:35], s63 offen offset:1024 sc1 lds
    s_add_u32 s63, s57, 1
    s_and_b32 s63, s63, 7
    s_lshl_b32 s63, s63, 18
    s_add_u32 m0, s60, 73728
    s_add_u32 s63, s63, s59
    buffer_load_dwordx4 v2, s[32:35], s63 offen sc1 lds
    buffer_load_dwordx4 v2, s[32:35], s63 offen offset:1024 sc1 lds
    s_add_u32 s63, s57, 2
    s_and_b32 s63, s63, 7
    s_lshl_b32 s63, s63, 18
    s_add_u32 m0, s60, 81920
    s_add_u32 s63, s63, s59
    buffer_load_dwordx4 v2, s[32:35], s63 offen sc1 lds
    buffer_load_dwordx4 v2, s[32:35], s63 offen offset:1024 sc1 lds
    s_add_u32 s63, s57, 3
    s_and_b32 s63, s63, 7
    s_lshl_b32 s63, s63, 18
    s_add_u32 m0, s60, 90112
    s_add_u32 s63, s63, s59
    buffer_load_dwordx4 v2, s[32:35], s63 offen sc1 lds
    buffer_load_dwordx4 v2, s[32:35], s63 offen offset:1024 sc1 lds
    s_waitcnt vmcnt(4)
    s_barrier
    s_add_u32 s63, s57, 4
    s_and_b32 s63, s63, 7
    s_lshl_b32 s63, s63, 18
    s_add_u32 m0, s60, 98304
    s_add_u32 s63, s63, s59
    buffer_load_dwordx4 v2, s[32:35], s63 offen sc1 lds
    buffer_load_dwordx4 v2, s[32:35], s63 offen offset:1024 sc1 lds
    s_add_u32 s63, s57, 5
    s_and_b32 s63, s63, 7
    s_lshl_b32 s63, s63, 18
    s_add_u32 m0, s60, 106496
    s_add_u32 s63, s63, s59
    buffer_load_dwordx4 v2, s[32:35], s63 offen sc1 lds
    buffer_load_dwordx4 v2, s[32:35], s63 offen offset:1024 sc1 lds
    s_waitcnt vmcnt(4)
    s_barrier
    s_add_u32 s63, s57, 6
    s_and_b32 s63, s63, 7
    s_lshl_b32 s63, s63, 18
    s_add_u32 m0, s60, 114688
    s_add_u32 s63, s63, s59
    buffer_load_dwordx4 v2, s[32:35], s63 offen sc1 lds
    buffer_load_dwordx4 v2, s[32:35], s63 offen offset:1024 sc1 lds
    s_add_u32 s63, s57, 7
    s_and_b32 s63, s63, 7
    s_lshl_b32 s63, s63, 18
    s_add_u32 m0, s60, 122880
    s_add_u32 s63, s63, s59
    buffer_load_dwordx4 v2, s[32:35], s63 offen sc1 lds
    buffer_load_dwordx4 v2, s[32:35], s63 offen offset:1024 sc1 lds
    s_waitcnt vmcnt(4)
    s_barrier
    s_waitcnt vmcnt(0)
    s_barrier
    s_endpgm
P1_M:
    s_sub_u32 s48, s3, 8
    s_lshl_b32 s49, s48, 13
    s_add_u32 s49, s49, 131072
    v_mov_b32 v10, s49
    v_mov_b32 v4, 0
    v_mov_b32 v5, 0
    v_mov_b32 v12, 0
    v_mov_b32 v13, 0
    v_mov_b32 v14, 0
    v_mov_b32 v15, 0
    ds_write_b128 v10, v[12:15] offset:6144
    ds_write_b128 v10, v[12:15] offset:6160
    v_min_u32 v3, 47, v1
    v_lshlrev_b32 v3, 2, v3
    v_add_u32 v3, 137280, v3
    ds_write_b32 v3, v12
    v_mov_b32 v3, 8192
    s_mov_b32 s60, 0x9e3779b1
    v_mov_b32 v6, 137472
    s_waitcnt lgkmcnt(0)
    s_add_u32 s36, s26, 0xf00000
    s_addc_u32 s37, s27, 0
    s_mov_b32 s38, 0xc0000
    s_mov_b32 s39, 0x20000
    buffer_load_dwordx2 v[166:167], v3, s[36:39], 0 offen sc1
    s_cmp_lt_u32 s53, 24
    s_cbranch_scc1 SVC_W2
    s_and_b32 s56, s53, 7
    s_lshl_b32 s56, s56, 2
    s_add_u32 s56, s56, s48
    s_mul_i32 s57, s56, 43
    s_lshr_b32 s57, s57, 8
    s_mul_i32 s58, s57, 6
    s_sub_u32 s58, s56, s58
    s_lshl_b32 s57, s57, 1
    s_add_u32 s57, s57, s58
    s_add_u32 s57, s57, 1
    s_and_b32 s57, s57, 7
    s_mul_i32 s57, s57, 196608
    s_and_b32 s59, s52, 1
    s_mul_i32 s59, s59, 6
    s_add_u32 s58, s58, s59
    s_lshl_b32 s58, s58, 8
    s_add_u32 s57, s57, s58
    s_mov_b32 s32, s6
    s_mov_b32 s33, s7
    s_mov_b32 s34, 0x180000
    s_mov_b32 s35, 0x20000
    v_mul_u32_u24 v7, 3072, v1
    s_cmp_ge_u32 s56, 24
    s_cbranch_scc1 SVC_W2
    buffer_load_dword v8, v7, s[32:35], s57 offen
    buffer_load_dword v9, v7, s[32:35], s57 offen offset:128
SVC_W2:
    s_and_b32 s54, s52, 1
    s_lshl_b32 s54, s54, 2
    s_and_b32 s55, s53, 3
    s_add_u32 s54, s54, s55
    s_lshr_b32 s55, s53, 2
    s_lshr_b32 s56, s52, 1
    s_mul_i32 s56, s56, 11
    s_add_u32 s68, s56, 12
    s_lshr_b32 s68, s68, 1
    s_add_u32 s56, s56, 1
    s_lshr_b32 s56, s56, 1
    s_add_u32 s56, s56, s55
    s_and_b32 s50, s48, 1
    s_lshr_b32 s51, s48, 1
    v_lshlrev_b32 v2, 4, v1
    v_lshrrev_b32 v10, 5, v1
    v_and_b32 v11, 31, v1
    v_lshlrev_b32 v11, 4, v11
    v_lshl_add_u32 v3, v10, 13, v11
    s_lshl_b32 s57, s48, 2
    s_add_u32 s57, s57, 137280
    v_mov_b32 v136, s57
    v_mov_b32 v137, 1
    s_mov_b32 s28, s12
    s_mov_b32 s29, s13
    s_mov_b32 s30, 0x560000
    s_mov_b32 s31, 0x20000
    s_add_u32 s32, s26, 0x600000
    s_addc_u32 s33, s27, 0
    s_mov_b32 s34, 0x200000
    s_mov_b32 s35, 0x20000
    s_add_u32 s40, s26, 0x200000
    s_addc_u32 s41, s27, 0
    s_mov_b32 s42, 0x400000
    s_mov_b32 s43, 0x20000
    s_waitcnt vmcnt(0)
    v_mul_lo_u32 v166, v166, s60
    v_add_u32 v167, 0x7f4a7c15, v167
    v_add_u32 v166, 1, v166
    ds_write_b64 v6, v[166:167]
    s_waitcnt lgkmcnt(0)
    s_barrier
    s_setprio 3
    s_cmp_ge_u32 s53, 24
    s_cbranch_scc1 M_SVC
    s_barrier
    s_barrier
    s_barrier
    s_barrier
    s_barrier
    s_barrier
    s_barrier
    s_cmp_ge_u32 s56, s68
    s_cbranch_scc1 M_IDLE
    s_mul_i32 s57, s48, 1409024
    s_lshl_b32 s58, s56, 7
    s_add_u32 s57, s57, s58
    s_lshl_b32 s58, s48, 19
    s_lshl_b32 s59, s54, 10
    s_add_u32 s58, s58, s59
    s_lshl_b32 s60, s51, 6
    s_lshl_b32 s61, s50, 9
    v_lshrrev_b32 v10, 3, v1
    v_mul_u32_u24 v10, 2752, v10
    v_bfe_u32 v11, v1, 4, 1
    v_lshlrev_b32 v11, 2, v11
    v_xor_b32 v11, v11, v1
    v_and_b32 v11, 7, v11
    v_lshl_add_u32 v4, v11, 4, v10
    v_add_u32 v5, 22016, v4
    v_xor_b32 v6, s61, v3
    v_xor_b32 v7, 512, v6
    s_and_b32 s63, s53, 3
    s_mul_i32 s63, s63, 2
    s_mul_i32 s62, s55, 1
    s_add_u32 s63, s63, s62
    v_lshrrev_b32 v10, 5, v1
    v_mul_u32_u24 v10, 8, v10
    v_bfe_u32 v11, v1, 2, 2
    v_add_u32 v10, v10, v11
    v_lshlrev_b32 v10, 7, v10
    v_bfe_u32 v11, v1, 3, 1
    v_lshl_add_u32 v10, v11, 6, v10
    v_bfe_u32 v11, v1, 4, 1
    v_lshl_add_u32 v10, v11, 5, v10
    v_and_b32 v11, 3, v1
    v_lshl_add_u32 v10, v11, 3, v10
    v_xor_b32 v10, s60, v10
    v_add_u32 v8, s49, v10
    v_xor_b32 v10, 64, v10
    v_add_u32 v9, s49, v10
    v_and_b32 v10, 7, v1
    v_lshlrev_b32 v10, 2, v10
    v_add_u32 v10, 137312, v10
    s_mov_b32 s62, 0x100000
M_GATE:
    ds_read_b32 v11, v10 offset:0
    s_waitcnt lgkmcnt(0)
    v_cmp_ne_u32 vcc, 1, v11
    s_sub_u32 s62, s62, 1
    s_cbranch_scc1 M_GATE_X
    s_cbranch_vccz M_GATE_X
    s_sleep 2
    s_branch M_GATE
M_GATE_X:
    s_lshl_b32 s61, s48, 11
    v_and_b32 v10, 15, v1
    v_lshlrev_b32 v10, 7, v10
    s_mov_b32 s62, 0x40000
M_HT:
    buffer_load_dwordx2 v[128:129], v10, s[36:39], s61 offen sc1
    s_waitcnt vmcnt(0)
    v_xor_b32 v128, v128, v166
    v_xor_b32 v129, v129, v167
    v_or_b32 v128, v128, v129
    v_cmp_ne_u32 vcc, 0, v128
    s_sub_u32 s62, s62, 1
    s_cbranch_scc1 M_HT_X
    s_cbranch_vccz M_HT_X
    s_sleep 4
    s_branch M_HT
M_HT_X:
    s_add_u32 m0, s49, 0
    s_add_u32 s64, s63, 0
    s_and_b32 s64, s64, 7
    s_add_u32 s64, s64, 0
    s_mul_i32 s64, s64, 44032
    s_add_u32 s64, s64, s57
    buffer_load_dwordx4 v4, s[28:31], s64 offen lds
    s_add_u32 m0, s49, 1024
    s_nop 0
    buffer_load_dwordx4 v5, s[28:31], s64 offen lds
    s_add_u32 m0, s49, 2048
    s_add_u32 s64, s63, 1
    s_and_b32 s64, s64, 7
    s_add_u32 s64, s64, 0
    s_mul_i32 s64, s64, 44032
    s_add_u32 s64, s64, s57
    buffer_load_dwordx4 v4, s[28:31], s64 offen lds
    s_add_u32 m0, s49, 3072
    s_nop 0
    buffer_load_dwordx4 v5, s[28:31], s64 offen lds
    s_add_u32 m0, s49, 4096
    s_add_u32 s64, s63, 2
    s_and_b32 s64, s64, 7
    s_add_u32 s64, s64, 0
    s_mul_i32 s64, s64, 44032
    s_add_u32 s64, s64, s57
    buffer_load_dwordx4 v4, s[28:31], s64 offen lds
    s_add_u32 m0, s49, 5120
    s_nop 0
    buffer_load_dwordx4 v5, s[28:31], s64 offen lds
    s_add_u32 s65, s63, 0
    s_and_b32 s65, s65, 7
    s_add_u32 s65, s65, 0
    s_mul_i32 s65, s65, 16384
    s_add_u32 s65, s65, s58
    buffer_load_dwordx4 v[28:31], v6, s[32:35], s65 offen sc1
    buffer_load_dwordx4 v[32:35], v7, s[32:35], s65 offen sc1
    s_add_u32 s65, s63, 1
    s_and_b32 s65, s65, 7
    s_add_u32 s65, s65, 0
    s_mul_i32 s65, s65, 16384
    s_add_u32 s65, s65, s58
    buffer_load_dwordx4 v[36:39], v6, s[32:35], s65 offen sc1
    buffer_load_dwordx4 v[40:43], v7, s[32:35], s65 offen sc1
    s_add_u32 s65, s63, 2
    s_and_b32 s65, s65, 7
    s_add_u32 s65, s65, 0
    s_mul_i32 s65, s65, 16384
    s_add_u32 s65, s65, s58
    buffer_load_dwordx4 v[44:47], v6, s[32:35], s65 offen sc1
    buffer_load_dwordx4 v[48:51], v7, s[32:35], s65 offen sc1
    s_waitcnt vmcnt(10)
    ds_read_b64_tr_b16 v[12:13], v8 offset:0
    ds_read_b64_tr_b16 v[14:15], v8 offset:512
    ds_read_b64_tr_b16 v[16:17], v9 offset:0
    ds_read_b64_tr_b16 v[18:19], v9 offset:512
    s_waitcnt lgkmcnt(0)
    s_add_u32 m0, s49, 0
    s_add_u32 s64, s63, 3
    s_and_b32 s64, s64, 7
    s_add_u32 s64, s64, 0
    s_mul_i32 s64, s64, 44032
    s_add_u32 s64, s64, s57
    buffer_load_dwordx4 v4, s[28:31], s64 offen lds
    s_add_u32 m0, s49, 1024
    s_nop 0
    buffer_load_dwordx4 v5, s[28:31], s64 offen lds
    s_setprio 0
    s_setprio 3
    v_and_b32 v132, 7, v1
    v_lshlrev_b32 v132, 2, v132
    v_add_u32 v132, 137312, v132
    s_mov_b32 s62, 0x100000
M_KV1D:
    ds_read_b32 v128, v132 offset:0
    s_waitcnt lgkmcnt(0)
    v_cmp_ne_u32 vcc, 1, v128
    s_sub_u32 s62, s62, 1
    s_cbranch_scc1 M_KV1D_X
    s_cbranch_vccz M_KV1D_X
    s_sleep 2
    s_branch M_KV1D
M_KV1D_X:
    s_lshl_b32 s44, s52, 5
    s_add_u32 s44, s44, s48
    s_lshl_b32 s44, s44, 7
    s_add_u32 s44, s44, 163840
    v_and_b32 v132, 7, v1
    v_lshlrev_b32 v132, 9, v132
    v_bfe_u32 v133, v1, 3, 1
    v_lshl_add_u32 v132, v133, 15, v132
    s_mov_b32 s62, 0x40000
M_KV1C:
    buffer_load_dwordx2 v[128:129], v132, s[36:39], s44 offen sc1
    s_waitcnt vmcnt(0)
    v_xor_b32 v128, v128, v166
    v_xor_b32 v129, v129, v167
    v_or_b32 v128, v128, v129
    v_cmp_ne_u32 vcc, 0, v128
    s_sub_u32 s62, s62, 1
    s_cbranch_scc1 M_KV1C_X
    s_cbranch_vccz M_KV1C_X
    s_sleep 2
    s_branch M_KV1C
M_KV1C_X:
    s_lshl_b32 s44, s52, 2
    s_and_b32 s45, s53, 3
    s_add_u32 s44, s44, s45
    s_lshl_b32 s44, s44, 17
    s_lshl_b32 s46, s48, 12
    s_lshr_b32 s45, s53, 2
    s_min_u32 s45, s45, 4
    s_add_u32 s45, s45, 2
    s_lshl_b32 s45, s45, 14
    s_add_u32 s45, s45, 16384
    s_cmp_ge_u32 s45, 0x20000
    s_cselect_b32 s45, 49152, s45
    s_add_u32 s47, s45, s46
    s_mov_b32 m0, s47
    s_add_u32 s47, s47, s44
    buffer_load_dwordx4 v2, s[40:43], s47 offen offset:0 sc1 lds
    buffer_load_dwordx4 v2, s[40:43], s47 offen offset:1024 sc1 lds
    buffer_load_dwordx4 v2, s[40:43], s47 offen offset:2048 sc1 lds
    buffer_load_dwordx4 v2, s[40:43], s47 offen offset:3072 sc1 lds
    s_add_u32 s45, s45, 16384
    s_cmp_ge_u32 s45, 0x20000
    s_cselect_b32 s45, 49152, s45
    s_add_u32 s47, s45, s46
    s_mov_b32 m0, s47
    s_add_u32 s47, s47, s44
    buffer_load_dwordx4 v2, s[40:43], s47 offen offset:0 sc1 lds
    buffer_load_dwordx4 v2, s[40:43], s47 offen offset:1024 sc1 lds
    buffer_load_dwordx4 v2, s[40:43], s47 offen offset:2048 sc1 lds
    buffer_load_dwordx4 v2, s[40:43], s47 offen offset:3072 sc1 lds
    s_add_u32 s45, s45, 16384
    s_cmp_ge_u32 s45, 0x20000
    s_cselect_b32 s45, 49152, s45
    s_add_u32 s47, s45, s46
    s_mov_b32 m0, s47
    s_add_u32 s47, s47, s44
    buffer_load_dwordx4 v2, s[40:43], s47 offen offset:0 sc1 lds
    buffer_load_dwordx4 v2, s[40:43], s47 offen offset:1024 sc1 lds
    buffer_load_dwordx4 v2, s[40:43], s47 offen offset:2048 sc1 lds
    buffer_load_dwordx4 v2, s[40:43], s47 offen offset:3072 sc1 lds
    s_add_u32 s45, s45, 16384
    s_cmp_ge_u32 s45, 0x20000
    s_cselect_b32 s45, 49152, s45
    s_add_u32 s47, s45, s46
    s_mov_b32 m0, s47
    s_add_u32 s47, s47, s44
    buffer_load_dwordx4 v2, s[40:43], s47 offen offset:0 sc1 lds
    buffer_load_dwordx4 v2, s[40:43], s47 offen offset:1024 sc1 lds
    buffer_load_dwordx4 v2, s[40:43], s47 offen offset:2048 sc1 lds
    buffer_load_dwordx4 v2, s[40:43], s47 offen offset:3072 sc1 lds
    s_add_u32 s45, s45, 16384
    s_cmp_ge_u32 s45, 0x20000
    s_cselect_b32 s45, 49152, s45
    s_add_u32 s47, s45, s46
    s_mov_b32 m0, s47
    s_add_u32 s47, s47, s44
    buffer_load_dwordx4 v2, s[40:43], s47 offen offset:0 sc1 lds
    buffer_load_dwordx4 v2, s[40:43], s47 offen offset:1024 sc1 lds
    buffer_load_dwordx4 v2, s[40:43], s47 offen offset:2048 sc1 lds
    buffer_load_dwordx4 v2, s[40:43], s47 offen offset:3072 sc1 lds
    s_setprio 0
    s_waitcnt vmcnt(26)
    v_mfma_f32_32x32x16_bf16 v[64:79], v[12:15], v[28:31], 0
    ds_read_b64_tr_b16 v[20:21], v8 offset:2048
    ds_read_b64_tr_b16 v[22:23], v8 offset:2560
    ds_read_b64_tr_b16 v[24:25], v9 offset:2048
    ds_read_b64_tr_b16 v[26:27], v9 offset:2560
    s_add_u32 s65, s63, 3
    s_and_b32 s65, s65, 7
    s_add_u32 s65, s65, 0
    s_mul_i32 s65, s65, 16384
    s_add_u32 s65, s65, s58
    buffer_load_dwordx4 v[52:55], v6, s[32:35], s65 offen sc1
    v_mfma_f32_32x32x16_bf16 v[80:95], v[12:15], v[32:35], 0
    buffer_load_dwordx4 v[56:59], v7, s[32:35], s65 offen sc1
    v_mfma_f32_32x32x16_bf16 v[96:111], v[16:19], v[28:31], 0
    s_waitcnt lgkmcnt(0)
    s_add_u32 m0, s49, 2048
    s_add_u32 s64, s63, 4
    s_and_b32 s64, s64, 7
    s_add_u32 s64, s64, 0
    s_mul_i32 s64, s64, 44032
    s_add_u32 s64, s64, s57
    buffer_load_dwordx4 v4, s[28:31], s64 offen lds
    v_mfma_f32_32x32x16_bf16 v[112:127], v[16:19], v[32:35], 0
    s_add_u32 m0, s49, 3072
    s_nop 0
    buffer_load_dwordx4 v5, s[28:31], s64 offen lds
    s_waitcnt vmcnt(28)
    v_mfma_f32_32x32x16_bf16 v[64:79], v[20:23], v[36:39], v[64:79]
    ds_read_b64_tr_b16 v[12:13], v8 offset:4096
    ds_read_b64_tr_b16 v[14:15], v8 offset:4608
    ds_read_b64_tr_b16 v[16:17], v9 offset:4096
    ds_read_b64_tr_b16 v[18:19], v9 offset:4608
    s_add_u32 s65, s63, 4
    s_and_b32 s65, s65, 7
    s_add_u32 s65, s65, 0
    s_mul_i32 s65, s65, 16384
    s_add_u32 s65, s65, s58
    buffer_load_dwordx4 v[28:31], v6, s[32:35], s65 offen sc1
    v_mfma_f32_32x32x16_bf16 v[80:95], v[20:23], v[40:43], v[80:95]
    buffer_load_dwordx4 v[32:35], v7, s[32:35], s65 offen sc1
    v_mfma_f32_32x32x16_bf16 v[96:111], v[24:27], v[36:39], v[96:111]
    s_waitcnt lgkmcnt(0)
    s_add_u32 m0, s49, 4096
    s_add_u32 s64, s63, 5
    s_and_b32 s64, s64, 7
    s_add_u32 s64, s64, 0
    s_mul_i32 s64, s64, 44032
    s_add_u32 s64, s64, s57
    buffer_load_dwordx4 v4, s[28:31], s64 offen lds
    v_mfma_f32_32x32x16_bf16 v[112:127], v[24:27], v[40:43], v[112:127]
    s_add_u32 m0, s49, 5120
    s_nop 0
    buffer_load_dwordx4 v5, s[28:31], s64 offen lds
    s_waitcnt vmcnt(28)
    v_mfma_f32_32x32x16_bf16 v[64:79], v[12:15], v[44:47], v[64:79]
    ds_read_b64_tr_b16 v[20:21], v8 offset:0
    ds_read_b64_tr_b16 v[22:23], v8 offset:512
    ds_read_b64_tr_b16 v[24:25], v9 offset:0
    ds_read_b64_tr_b16 v[26:27], v9 offset:512
    s_add_u32 s65, s63, 5
    s_and_b32 s65, s65, 7
    s_add_u32 s65, s65, 0
    s_mul_i32 s65, s65, 16384
    s_add_u32 s65, s65, s58
    buffer_load_dwordx4 v[36:39], v6, s[32:35], s65 offen sc1
    v_mfma_f32_32x32x16_bf16 v[80:95], v[12:15], v[48:51], v[80:95]
    buffer_load_dwordx4 v[40:43], v7, s[32:35], s65 offen sc1
    v_mfma_f32_32x32x16_bf16 v[96:111], v[16:19], v[44:47], v[96:111]
    s_waitcnt lgkmcnt(0)
    s_add_u32 m0, s49, 0
    s_add_u32 s64, s63, 6
    s_and_b32 s64, s64, 7
    s_add_u32 s64, s64, 0
    s_mul_i32 s64, s64, 44032
    s_add_u32 s64, s64, s57
    buffer_load_dwordx4 v4, s[28:31], s64 offen lds
    v_mfma_f32_32x32x16_bf16 v[112:127], v[16:19], v[48:51], v[112:127]
    s_add_u32 m0, s49, 1024
    s_nop 0
    buffer_load_dwordx4 v5, s[28:31], s64 offen lds
    s_waitcnt vmcnt(12)
    ds_write_b32 v136, v137
    s_waitcnt vmcnt(8)
    v_mfma_f32_32x32x16_bf16 v[64:79], v[20:23], v[52:55], v[64:79]
    ds_read_b64_tr_b16 v[12:13], v8 offset:2048
    ds_read_b64_tr_b16 v[14:15], v8 offset:2560
    ds_read_b64_tr_b16 v[16:17], v9 offset:2048
    ds_read_b64_tr_b16 v[18:19], v9 offset:2560
    s_add_u32 s65, s63, 6
    s_and_b32 s65, s65, 7
    s_add_u32 s65, s65, 0
    s_mul_i32 s65, s65, 16384
    s_add_u32 s65, s65, s58
    buffer_load_dwordx4 v[44:47], v6, s[32:35], s65 offen sc1
    v_mfma_f32_32x32x16_bf16 v[80:95], v[20:23], v[56:59], v[80:95]
    buffer_load_dwordx4 v[48:51], v7, s[32:35], s65 offen sc1
    v_mfma_f32_32x32x16_bf16 v[96:111], v[24:27], v[52:55], v[96:111]
    s_waitcnt lgkmcnt(0)
    s_add_u32 m0, s49, 2048
    s_add_u32 s64, s63, 7
    s_and_b32 s64, s64, 7
    s_add_u32 s64, s64, 0
    s_mul_i32 s64, s64, 44032
    s_add_u32 s64, s64, s57
    buffer_load_dwordx4 v4, s[28:31], s64 offen lds
    v_mfma_f32_32x32x16_bf16 v[112:127], v[24:27], v[56:59], v[112:127]
    s_add_u32 m0, s49, 3072
    s_nop 0
    buffer_load_dwordx4 v5, s[28:31], s64 offen lds
    s_waitcnt vmcnt(8)
    v_mfma_f32_32x32x16_bf16 v[64:79], v[12:15], v[28:31], v[64:79]
    ds_read_b64_tr_b16 v[20:21], v8 offset:4096
    ds_read_b64_tr_b16 v[22:23], v8 offset:4608
    ds_read_b64_tr_b16 v[24:25], v9 offset:4096
    ds_read_b64_tr_b16 v[26:27], v9 offset:4608
    s_add_u32 s65, s63, 7
    s_and_b32 s65, s65, 7
    s_add_u32 s65, s65, 0
    s_mul_i32 s65, s65, 16384
    s_add_u32 s65, s65, s58
    buffer_load_dwordx4 v[52:55], v6, s[32:35], s65 offen sc1
    v_mfma_f32_32x32x16_bf16 v[80:95], v[12:15], v[32:35], v[80:95]
    buffer_load_dwordx4 v[56:59], v7, s[32:35], s65 offen sc1
    v_mfma_f32_32x32x16_bf16 v[96:111], v[16:19], v[28:31], v[96:111]
    s_waitcnt lgkmcnt(0)
    s_add_u32 m0, s49, 4096
    s_add_u32 s64, s63, 0
    s_and_b32 s64, s64, 7
    s_add_u32 s64, s64, 8
    s_mul_i32 s64, s64, 44032
    s_add_u32 s64, s64, s57
    buffer_load_dwordx4 v4, s[28:31], s64 offen lds
    v_mfma_f32_32x32x16_bf16 v[112:127], v[16:19], v[32:35], v[112:127]
    s_add_u32 m0, s49, 5120
    s_nop 0
    buffer_load_dwordx4 v5, s[28:31], s64 offen lds
    s_waitcnt vmcnt(8)
    v_mfma_f32_32x32x16_bf16 v[64:79], v[20:23], v[36:39], v[64:79]
    ds_read_b64_tr_b16 v[12:13], v8 offset:0
    ds_read_b64_tr_b16 v[14:15], v8 offset:512
    ds_read_b64_tr_b16 v[16:17], v9 offset:0
    ds_read_b64_tr_b16 v[18:19], v9 offset:512
    s_add_u32 s65, s63, 0
    s_and_b32 s65, s65, 7
    s_add_u32 s65, s65, 8
    s_mul_i32 s65, s65, 16384
    s_add_u32 s65, s65, s58
    buffer_load_dwordx4 v[28:31], v6, s[32:35], s65 offen sc1
    v_mfma_f32_32x32x16_bf16 v[80:95], v[20:23], v[40:43], v[80:95]
    buffer_load_dwordx4 v[32:35], v7, s[32:35], s65 offen sc1
    v_mfma_f32_32x32x16_bf16 v[96:111], v[24:27], v[36:39], v[96:111]
    s_waitcnt lgkmcnt(0)
    s_add_u32 m0, s49, 0
    s_add_u32 s64, s63, 1
    s_and_b32 s64, s64, 7
    s_add_u32 s64, s64, 8
    s_mul_i32 s64, s64, 44032
    s_add_u32 s64, s64, s57
    buffer_load_dwordx4 v4, s[28:31], s64 offen lds
    v_mfma_f32_32x32x16_bf16 v[112:127], v[24:27], v[40:43], v[112:127]
    s_add_u32 m0, s49, 1024
    s_nop 0
    buffer_load_dwordx4 v5, s[28:31], s64 offen lds
    s_waitcnt vmcnt(8)
    v_mfma_f32_32x32x16_bf16 v[64:79], v[12:15], v[44:47], v[64:79]
    ds_read_b64_tr_b16 v[20:21], v8 offset:2048
    ds_read_b64_tr_b16 v[22:23], v8 offset:2560
    ds_read_b64_tr_b16 v[24:25], v9 offset:2048
    ds_read_b64_tr_b16 v[26:27], v9 offset:2560
    s_add_u32 s65, s63, 1
    s_and_b32 s65, s65, 7
    s_add_u32 s65, s65, 8
    s_mul_i32 s65, s65, 16384
    s_add_u32 s65, s65, s58
    buffer_load_dwordx4 v[36:39], v6, s[32:35], s65 offen sc1
    v_mfma_f32_32x32x16_bf16 v[80:95], v[12:15], v[48:51], v[80:95]
    buffer_load_dwordx4 v[40:43], v7, s[32:35], s65 offen sc1
    v_mfma_f32_32x32x16_bf16 v[96:111], v[16:19], v[44:47], v[96:111]
    s_waitcnt lgkmcnt(0)
    s_add_u32 m0, s49, 2048
    s_add_u32 s64, s63, 2
    s_and_b32 s64, s64, 7
    s_add_u32 s64, s64, 8
    s_mul_i32 s64, s64, 44032
    s_add_u32 s64, s64, s57
    buffer_load_dwordx4 v4, s[28:31], s64 offen lds
    v_mfma_f32_32x32x16_bf16 v[112:127], v[16:19], v[48:51], v[112:127]
    s_add_u32 m0, s49, 3072
    s_nop 0
    buffer_load_dwordx4 v5, s[28:31], s64 offen lds
    s_waitcnt vmcnt(8)
    v_mfma_f32_32x32x16_bf16 v[64:79], v[20:23], v[52:55], v[64:79]
    ds_read_b64_tr_b16 v[12:13], v8 offset:4096
    ds_read_b64_tr_b16 v[14:15], v8 offset:4608
    ds_read_b64_tr_b16 v[16:17], v9 offset:4096
    ds_read_b64_tr_b16 v[18:19], v9 offset:4608
    s_add_u32 s65, s63, 2
    s_and_b32 s65, s65, 7
    s_add_u32 s65, s65, 8
    s_mul_i32 s65, s65, 16384
    s_add_u32 s65, s65, s58
    buffer_load_dwordx4 v[44:47], v6, s[32:35], s65 offen sc1
    v_mfma_f32_32x32x16_bf16 v[80:95], v[20:23], v[56:59], v[80:95]
    buffer_load_dwordx4 v[48:51], v7, s[32:35], s65 offen sc1
    v_mfma_f32_32x32x16_bf16 v[96:111], v[24:27], v[52:55], v[96:111]
    s_waitcnt lgkmcnt(0)
    s_add_u32 m0, s49, 4096
    s_add_u32 s64, s63, 3
    s_and_b32 s64, s64, 7
    s_add_u32 s64, s64, 8
    s_mul_i32 s64, s64, 44032
    s_add_u32 s64, s64, s57
    buffer_load_dwordx4 v4, s[28:31], s64 offen lds
    v_mfma_f32_32x32x16_bf16 v[112:127], v[24:27], v[56:59], v[112:127]
    s_add_u32 m0, s49, 5120
    s_nop 0
    buffer_load_dwordx4 v5, s[28:31], s64 offen lds
    s_waitcnt vmcnt(8)
    v_mfma_f32_32x32x16_bf16 v[64:79], v[12:15], v[28:31], v[64:79]
    ds_read_b64_tr_b16 v[20:21], v8 offset:0
    ds_read_b64_tr_b16 v[22:23], v8 offset:512
    ds_read_b64_tr_b16 v[24:25], v9 offset:0
    ds_read_b64_tr_b16 v[26:27], v9 offset:512
    s_add_u32 s65, s63, 3
    s_and_b32 s65, s65, 7
    s_add_u32 s65, s65, 8
    s_mul_i32 s65, s65, 16384
    s_add_u32 s65, s65, s58
    buffer_load_dwordx4 v[52:55], v6, s[32:35], s65 offen sc1
    v_mfma_f32_32x32x16_bf16 v[80:95], v[12:15], v[32:35], v[80:95]
    buffer_load_dwordx4 v[56:59], v7, s[32:35], s65 offen sc1
    v_mfma_f32_32x32x16_bf16 v[96:111], v[16:19], v[28:31], v[96:111]
    s_waitcnt lgkmcnt(0)
    s_add_u32 m0, s49, 0
    s_add_u32 s64, s63, 4
    s_and_b32 s64, s64, 7
    s_add_u32 s64, s64, 8
    s_mul_i32 s64, s64, 44032
    s_add_u32 s64, s64, s57
    buffer_load_dwordx4 v4, s[28:31], s64 offen lds
    v_mfma_f32_32x32x16_bf16 v[112:127], v[16:19], v[32:35], v[112:127]
    s_add_u32 m0, s49, 1024
    s_nop 0
    buffer_load_dwordx4 v5, s[28:31], s64 offen lds
    s_waitcnt vmcnt(8)
    v_mfma_f32_32x32x16_bf16 v[64:79], v[20:23], v[36:39], v[64:79]
    ds_read_b64_tr_b16 v[12:13], v8 offset:2048
    ds_read_b64_tr_b16 v[14:15], v8 offset:2560
    ds_read_b64_tr_b16 v[16:17], v9 offset:2048
    ds_read_b64_tr_b16 v[18:19], v9 offset:2560
    s_add_u32 s65, s63, 4
    s_and_b32 s65, s65, 7
    s_add_u32 s65, s65, 8
    s_mul_i32 s65, s65, 16384
    s_add_u32 s65, s65, s58
    buffer_load_dwordx4 v[28:31], v6, s[32:35], s65 offen sc1
    v_mfma_f32_32x32x16_bf16 v[80:95], v[20:23], v[40:43], v[80:95]
    buffer_load_dwordx4 v[32:35], v7, s[32:35], s65 offen sc1
    v_mfma_f32_32x32x16_bf16 v[96:111], v[24:27], v[36:39], v[96:111]
    s_waitcnt lgkmcnt(0)
    s_add_u32 m0, s49, 2048
    s_add_u32 s64, s63, 5
    s_and_b32 s64, s64, 7
    s_add_u32 s64, s64, 8
    s_mul_i32 s64, s64, 44032
    s_add_u32 s64, s64, s57
    buffer_load_dwordx4 v4, s[28:31], s64 offen lds
    v_mfma_f32_32x32x16_bf16 v[112:127], v[24:27], v[40:43], v[112:127]
    s_add_u32 m0, s49, 3072
    s_nop 0
    buffer_load_dwordx4 v5, s[28:31], s64 offen lds
    s_waitcnt vmcnt(8)
    v_mfma_f32_32x32x16_bf16 v[64:79], v[12:15], v[44:47], v[64:79]
    ds_read_b64_tr_b16 v[20:21], v8 offset:4096
    ds_read_b64_tr_b16 v[22:23], v8 offset:4608
    ds_read_b64_tr_b16 v[24:25], v9 offset:4096
    ds_read_b64_tr_b16 v[26:27], v9 offset:4608
    s_add_u32 s65, s63, 5
    s_and_b32 s65, s65, 7
    s_add_u32 s65, s65, 8
    s_mul_i32 s65, s65, 16384
    s_add_u32 s65, s65, s58
    buffer_load_dwordx4 v[36:39], v6, s[32:35], s65 offen sc1
    v_mfma_f32_32x32x16_bf16 v[80:95], v[12:15], v[48:51], v[80:95]
    buffer_load_dwordx4 v[40:43], v7, s[32:35], s65 offen sc1
    v_mfma_f32_32x32x16_bf16 v[96:111], v[16:19], v[44:47], v[96:111]
    s_waitcnt lgkmcnt(0)
    s_add_u32 m0, s49, 4096
    s_add_u32 s64, s63, 6
    s_and_b32 s64, s64, 7
    s_add_u32 s64, s64, 8
    s_mul_i32 s64, s64, 44032
    s_add_u32 s64, s64, s57
    buffer_load_dwordx4 v4, s[28:31], s64 offen lds
    v_mfma_f32_32x32x16_bf16 v[112:127], v[16:19], v[48:51], v[112:127]
    s_add_u32 m0, s49, 5120
    s_nop 0
    buffer_load_dwordx4 v5, s[28:31], s64 offen lds
    s_waitcnt vmcnt(8)
    v_mfma_f32_32x32x16_bf16 v[64:79], v[20:23], v[52:55], v[64:79]
    ds_read_b64_tr_b16 v[12:13], v8 offset:0
    ds_read_b64_tr_b16 v[14:15], v8 offset:512
    ds_read_b64_tr_b16 v[16:17], v9 offset:0
    ds_read_b64_tr_b16 v[18:19], v9 offset:512
    s_add_u32 s65, s63, 6
    s_and_b32 s65, s65, 7
    s_add_u32 s65, s65, 8
    s_mul_i32 s65, s65, 16384
    s_add_u32 s65, s65, s58
    buffer_load_dwordx4 v[44:47], v6, s[32:35], s65 offen sc1
    v_mfma_f32_32x32x16_bf16 v[80:95], v[20:23], v[56:59], v[80:95]
    buffer_load_dwordx4 v[48:51], v7, s[32:35], s65 offen sc1
    v_mfma_f32_32x32x16_bf16 v[96:111], v[24:27], v[52:55], v[96:111]
    s_waitcnt lgkmcnt(0)
    s_add_u32 m0, s49, 0
    s_add_u32 s64, s63, 7
    s_and_b32 s64, s64, 7
    s_add_u32 s64, s64, 8
    s_mul_i32 s64, s64, 44032
    s_add_u32 s64, s64, s57
    buffer_load_dwordx4 v4, s[28:31], s64 offen lds
    v_mfma_f32_32x32x16_bf16 v[112:127], v[24:27], v[56:59], v[112:127]
    s_add_u32 m0, s49, 1024
    s_nop 0
    buffer_load_dwordx4 v5, s[28:31], s64 offen lds
    s_waitcnt vmcnt(8)
    v_mfma_f32_32x32x16_bf16 v[64:79], v[12:15], v[28:31], v[64:79]
    ds_read_b64_tr_b16 v[20:21], v8 offset:2048
    ds_read_b64_tr_b16 v[22:23], v8 offset:2560
    ds_read_b64_tr_b16 v[24:25], v9 offset:2048
    ds_read_b64_tr_b16 v[26:27], v9 offset:2560
    s_add_u32 s65, s63, 7
    s_and_b32 s65, s65, 7
    s_add_u32 s65, s65, 8
    s_mul_i32 s65, s65, 16384
    s_add_u32 s65, s65, s58
    buffer_load_dwordx4 v[52:55], v6, s[32:35], s65 offen sc1
    v_mfma_f32_32x32x16_bf16 v[80:95], v[12:15], v[32:35], v[80:95]
    buffer_load_dwordx4 v[56:59], v7, s[32:35], s65 offen sc1
    v_mfma_f32_32x32x16_bf16 v[96:111], v[16:19], v[28:31], v[96:111]
    s_waitcnt lgkmcnt(0)
    s_add_u32 m0, s49, 2048
    s_add_u32 s64, s63, 0
    s_and_b32 s64, s64, 7
    s_add_u32 s64, s64, 16
    s_mul_i32 s64, s64, 44032
    s_add_u32 s64, s64, s57
    buffer_load_dwordx4 v4, s[28:31], s64 offen lds
    v_mfma_f32_32x32x16_bf16 v[112:127], v[16:19], v[32:35], v[112:127]
    s_add_u32 m0, s49, 3072
    s_nop 0
    buffer_load_dwordx4 v5, s[28:31], s64 offen lds
    s_waitcnt vmcnt(8)
    v_mfma_f32_32x32x16_bf16 v[64:79], v[20:23], v[36:39], v[64:79]
    ds_read_b64_tr_b16 v[12:13], v8 offset:4096
    ds_read_b64_tr_b16 v[14:15], v8 offset:4608
    ds_read_b64_tr_b16 v[16:17], v9 offset:4096
    ds_read_b64_tr_b16 v[18:19], v9 offset:4608
    s_add_u32 s65, s63, 0
    s_and_b32 s65, s65, 7
    s_add_u32 s65, s65, 16
    s_mul_i32 s65, s65, 16384
    s_add_u32 s65, s65, s58
    buffer_load_dwordx4 v[28:31], v6, s[32:35], s65 offen sc1
    v_mfma_f32_32x32x16_bf16 v[80:95], v[20:23], v[40:43], v[80:95]
    buffer_load_dwordx4 v[32:35], v7, s[32:35], s65 offen sc1
    v_mfma_f32_32x32x16_bf16 v[96:111], v[24:27], v[36:39], v[96:111]
    s_waitcnt lgkmcnt(0)
    s_add_u32 m0, s49, 4096
    s_add_u32 s64, s63, 1
    s_and_b32 s64, s64, 7
    s_add_u32 s64, s64, 16
    s_mul_i32 s64, s64, 44032
    s_add_u32 s64, s64, s57
    buffer_load_dwordx4 v4, s[28:31], s64 offen lds
    v_mfma_f32_32x32x16_bf16 v[112:127], v[24:27], v[40:43], v[112:127]
    s_add_u32 m0, s49, 5120
    s_nop 0
    buffer_load_dwordx4 v5, s[28:31], s64 offen lds
    s_waitcnt vmcnt(8)
    v_mfma_f32_32x32x16_bf16 v[64:79], v[12:15], v[44:47], v[64:79]
    ds_read_b64_tr_b16 v[20:21], v8 offset:0
    ds_read_b64_tr_b16 v[22:23], v8 offset:512
    ds_read_b64_tr_b16 v[24:25], v9 offset:0
    ds_read_b64_tr_b16 v[26:27], v9 offset:512
    s_add_u32 s65, s63, 1
    s_and_b32 s65, s65, 7
    s_add_u32 s65, s65, 16
    s_mul_i32 s65, s65, 16384
    s_add_u32 s65, s65, s58
    buffer_load_dwordx4 v[36:39], v6, s[32:35], s65 offen sc1
    v_mfma_f32_32x32x16_bf16 v[80:95], v[12:15], v[48:51], v[80:95]
    buffer_load_dwordx4 v[40:43], v7, s[32:35], s65 offen sc1
    v_mfma_f32_32x32x16_bf16 v[96:111], v[16:19], v[44:47], v[96:111]
    s_waitcnt lgkmcnt(0)
    s_add_u32 m0, s49, 0
    s_add_u32 s64, s63, 2
    s_and_b32 s64, s64, 7
    s_add_u32 s64, s64, 16
    s_mul_i32 s64, s64, 44032
    s_add_u32 s64, s64, s57
    buffer_load_dwordx4 v4, s[28:31], s64 offen lds
    v_mfma_f32_32x32x16_bf16 v[112:127], v[16:19], v[48:51], v[112:127]
    s_add_u32 m0, s49, 1024
    s_nop 0
    buffer_load_dwordx4 v5, s[28:31], s64 offen lds
    s_waitcnt vmcnt(8)
    v_mfma_f32_32x32x16_bf16 v[64:79], v[20:23], v[52:55], v[64:79]
    ds_read_b64_tr_b16 v[12:13], v8 offset:2048
    ds_read_b64_tr_b16 v[14:15], v8 offset:2560
    ds_read_b64_tr_b16 v[16:17], v9 offset:2048
    ds_read_b64_tr_b16 v[18:19], v9 offset:2560
    s_add_u32 s65, s63, 2
    s_and_b32 s65, s65, 7
    s_add_u32 s65, s65, 16
    s_mul_i32 s65, s65, 16384
    s_add_u32 s65, s65, s58
    buffer_load_dwordx4 v[44:47], v6, s[32:35], s65 offen sc1
    v_mfma_f32_32x32x16_bf16 v[80:95], v[20:23], v[56:59], v[80:95]
    buffer_load_dwordx4 v[48:51], v7, s[32:35], s65 offen sc1
    v_mfma_f32_32x32x16_bf16 v[96:111], v[24:27], v[52:55], v[96:111]
    s_waitcnt lgkmcnt(0)
    s_add_u32 m0, s49, 2048
    s_add_u32 s64, s63, 3
    s_and_b32 s64, s64, 7
    s_add_u32 s64, s64, 16
    s_mul_i32 s64, s64, 44032
    s_add_u32 s64, s64, s57
    buffer_load_dwordx4 v4, s[28:31], s64 offen lds
    v_mfma_f32_32x32x16_bf16 v[112:127], v[24:27], v[56:59], v[112:127]
    s_add_u32 m0, s49, 3072
    s_nop 0
    buffer_load_dwordx4 v5, s[28:31], s64 offen lds
    s_waitcnt vmcnt(8)
    v_mfma_f32_32x32x16_bf16 v[64:79], v[12:15], v[28:31], v[64:79]
    ds_read_b64_tr_b16 v[20:21], v8 offset:4096
    ds_read_b64_tr_b16 v[22:23], v8 offset:4608
    ds_read_b64_tr_b16 v[24:25], v9 offset:4096
    ds_read_b64_tr_b16 v[26:27], v9 offset:4608
    s_add_u32 s65, s63, 3
    s_and_b32 s65, s65, 7
    s_add_u32 s65, s65, 16
    s_mul_i32 s65, s65, 16384
    s_add_u32 s65, s65, s58
    buffer_load_dwordx4 v[52:55], v6, s[32:35], s65 offen sc1
    v_mfma_f32_32x32x16_bf16 v[80:95], v[12:15], v[32:35], v[80:95]
    buffer_load_dwordx4 v[56:59], v7, s[32:35], s65 offen sc1
    v_mfma_f32_32x32x16_bf16 v[96:111], v[16:19], v[28:31], v[96:111]
    s_waitcnt lgkmcnt(0)
    s_add_u32 m0, s49, 4096
    s_add_u32 s64, s63, 4
    s_and_b32 s64, s64, 7
    s_add_u32 s64, s64, 16
    s_mul_i32 s64, s64, 44032
    s_add_u32 s64, s64, s57
    buffer_load_dwordx4 v4, s[28:31], s64 offen lds
    v_mfma_f32_32x32x16_bf16 v[112:127], v[16:19], v[32:35], v[112:127]
    s_add_u32 m0, s49, 5120
    s_nop 0
    buffer_load_dwordx4 v5, s[28:31], s64 offen lds
    s_waitcnt vmcnt(8)
    v_mfma_f32_32x32x16_bf16 v[64:79], v[20:23], v[36:39], v[64:79]
    ds_read_b64_tr_b16 v[12:13], v8 offset:0
    ds_read_b64_tr_b16 v[14:15], v8 offset:512
    ds_read_b64_tr_b16 v[16:17], v9 offset:0
    ds_read_b64_tr_b16 v[18:19], v9 offset:512
    s_add_u32 s65, s63, 4
    s_and_b32 s65, s65, 7
    s_add_u32 s65, s65, 16
    s_mul_i32 s65, s65, 16384
    s_add_u32 s65, s65, s58
    buffer_load_dwordx4 v[28:31], v6, s[32:35], s65 offen sc1
    v_mfma_f32_32x32x16_bf16 v[80:95], v[20:23], v[40:43], v[80:95]
    buffer_load_dwordx4 v[32:35], v7, s[32:35], s65 offen sc1
    v_mfma_f32_32x32x16_bf16 v[96:111], v[24:27], v[36:39], v[96:111]
    s_waitcnt lgkmcnt(0)
    s_add_u32 m0, s49, 0
    s_add_u32 s64, s63, 5
    s_and_b32 s64, s64, 7
    s_add_u32 s64, s64, 16
    s_mul_i32 s64, s64, 44032
    s_add_u32 s64, s64, s57
    buffer_load_dwordx4 v4, s[28:31], s64 offen lds
    v_mfma_f32_32x32x16_bf16 v[112:127], v[24:27], v[40:43], v[112:127]
    s_add_u32 m0, s49, 1024
    s_nop 0
    buffer_load_dwordx4 v5, s[28:31], s64 offen lds
    s_waitcnt vmcnt(8)
    v_mfma_f32_32x32x16_bf16 v[64:79], v[12:15], v[44:47], v[64:79]
    ds_read_b64_tr_b16 v[20:21], v8 offset:2048
    ds_read_b64_tr_b16 v[22:23], v8 offset:2560
    ds_read_b64_tr_b16 v[24:25], v9 offset:2048
    ds_read_b64_tr_b16 v[26:27], v9 offset:2560
    s_add_u32 s65, s63, 5
    s_and_b32 s65, s65, 7
    s_add_u32 s65, s65, 16
    s_mul_i32 s65, s65, 16384
    s_add_u32 s65, s65, s58
    buffer_load_dwordx4 v[36:39], v6, s[32:35], s65 offen sc1
    v_mfma_f32_32x32x16_bf16 v[80:95], v[12:15], v[48:51], v[80:95]
    buffer_load_dwordx4 v[40:43], v7, s[32:35], s65 offen sc1
    v_mfma_f32_32x32x16_bf16 v[96:111], v[16:19], v[44:47], v[96:111]
    s_waitcnt lgkmcnt(0)
    s_add_u32 m0, s49, 2048
    s_add_u32 s64, s63, 6
    s_and_b32 s64, s64, 7
    s_add_u32 s64, s64, 16
    s_mul_i32 s64, s64, 44032
    s_add_u32 s64, s64, s57
    buffer_load_dwordx4 v4, s[28:31], s64 offen lds
    v_mfma_f32_32x32x16_bf16 v[112:127], v[16:19], v[48:51], v[112:127]
    s_add_u32 m0, s49, 3072
    s_nop 0
    buffer_load_dwordx4 v5, s[28:31], s64 offen lds
    s_waitcnt vmcnt(8)
    v_mfma_f32_32x32x16_bf16 v[64:79], v[20:23], v[52:55], v[64:79]
    ds_read_b64_tr_b16 v[12:13], v8 offset:4096
    ds_read_b64_tr_b16 v[14:15], v8 offset:4608
    ds_read_b64_tr_b16 v[16:17], v9 offset:4096
    ds_read_b64_tr_b16 v[18:19], v9 offset:4608
    s_add_u32 s65, s63, 6
    s_and_b32 s65, s65, 7
    s_add_u32 s65, s65, 16
    s_mul_i32 s65, s65, 16384
    s_add_u32 s65, s65, s58
    buffer_load_dwordx4 v[44:47], v6, s[32:35], s65 offen sc1
    v_mfma_f32_32x32x16_bf16 v[80:95], v[20:23], v[56:59], v[80:95]
    buffer_load_dwordx4 v[48:51], v7, s[32:35], s65 offen sc1
    v_mfma_f32_32x32x16_bf16 v[96:111], v[24:27], v[52:55], v[96:111]
    s_waitcnt lgkmcnt(0)
    s_add_u32 m0, s49, 4096
    s_add_u32 s64, s63, 7
    s_and_b32 s64, s64, 7
    s_add_u32 s64, s64, 16
    s_mul_i32 s64, s64, 44032
    s_add_u32 s64, s64, s57
    buffer_load_dwordx4 v4, s[28:31], s64 offen lds
    v_mfma_f32_32x32x16_bf16 v[112:127], v[24:27], v[56:59], v[112:127]
    s_add_u32 m0, s49, 5120
    s_nop 0
    buffer_load_dwordx4 v5, s[28:31], s64 offen lds
    s_waitcnt vmcnt(8)
    v_mfma_f32_32x32x16_bf16 v[64:79], v[12:15], v[28:31], v[64:79]
    ds_read_b64_tr_b16 v[20:21], v8 offset:0
    ds_read_b64_tr_b16 v[22:23], v8 offset:512
    ds_read_b64_tr_b16 v[24:25], v9 offset:0
    ds_read_b64_tr_b16 v[26:27], v9 offset:512
    s_add_u32 s65, s63, 7
    s_and_b32 s65, s65, 7
    s_add_u32 s65, s65, 16
    s_mul_i32 s65, s65, 16384
    s_add_u32 s65, s65, s58
    buffer_load_dwordx4 v[52:55], v6, s[32:35], s65 offen sc1
    v_mfma_f32_32x32x16_bf16 v[80:95], v[12:15], v[32:35], v[80:95]
    buffer_load_dwordx4 v[56:59], v7, s[32:35], s65 offen sc1
    v_mfma_f32_32x32x16_bf16 v[96:111], v[16:19], v[28:31], v[96:111]
    s_waitcnt lgkmcnt(0)
    s_add_u32 m0, s49, 0
    s_add_u32 s64, s63, 0
    s_and_b32 s64, s64, 7
    s_add_u32 s64, s64, 24
    s_mul_i32 s64, s64, 44032
    s_add_u32 s64, s64, s57
    buffer_load_dwordx4 v4, s[28:31], s64 offen lds
    v_mfma_f32_32x32x16_bf16 v[112:127], v[16:19], v[32:35], v[112:127]
    s_add_u32 m0, s49, 1024
    s_nop 0
    buffer_load_dwordx4 v5, s[28:31], s64 offen lds
    s_waitcnt vmcnt(8)
    v_mfma_f32_32x32x16_bf16 v[64:79], v[20:23], v[36:39], v[64:79]
    ds_read_b64_tr_b16 v[12:13], v8 offset:2048
    ds_read_b64_tr_b16 v[14:15], v8 offset:2560
    ds_read_b64_tr_b16 v[16:17], v9 offset:2048
    ds_read_b64_tr_b16 v[18:19], v9 offset:2560
    s_add_u32 s65, s63, 0
    s_and_b32 s65, s65, 7
    s_add_u32 s65, s65, 24
    s_mul_i32 s65, s65, 16384
    s_add_u32 s65, s65, s58
    buffer_load_dwordx4 v[28:31], v6, s[32:35], s65 offen sc1
    v_mfma_f32_32x32x16_bf16 v[80:95], v[20:23], v[40:43], v[80:95]
    buffer_load_dwordx4 v[32:35], v7, s[32:35], s65 offen sc1
    v_mfma_f32_32x32x16_bf16 v[96:111], v[24:27], v[36:39], v[96:111]
    s_waitcnt lgkmcnt(0)
    s_add_u32 m0, s49, 2048
    s_add_u32 s64, s63, 1
    s_and_b32 s64, s64, 7
    s_add_u32 s64, s64, 24
    s_mul_i32 s64, s64, 44032
    s_add_u32 s64, s64, s57
    buffer_load_dwordx4 v4, s[28:31], s64 offen lds
    v_mfma_f32_32x32x16_bf16 v[112:127], v[24:27], v[40:43], v[112:127]
    s_add_u32 m0, s49, 3072
    s_nop 0
    buffer_load_dwordx4 v5, s[28:31], s64 offen lds
    s_waitcnt vmcnt(8)
    v_mfma_f32_32x32x16_bf16 v[64:79], v[12:15], v[44:47], v[64:79]
    ds_read_b64_tr_b16 v[20:21], v8 offset:4096
    ds_read_b64_tr_b16 v[22:23], v8 offset:4608
    ds_read_b64_tr_b16 v[24:25], v9 offset:4096
    ds_read_b64_tr_b16 v[26:27], v9 offset:4608
    s_add_u32 s65, s63, 1
    s_and_b32 s65, s65, 7
    s_add_u32 s65, s65, 24
    s_mul_i32 s65, s65, 16384
    s_add_u32 s65, s65, s58
    buffer_load_dwordx4 v[36:39], v6, s[32:35], s65 offen sc1
    v_mfma_f32_32x32x16_bf16 v[80:95], v[12:15], v[48:51], v[80:95]
    buffer_load_dwordx4 v[40:43], v7, s[32:35], s65 offen sc1
    v_mfma_f32_32x32x16_bf16 v[96:111], v[16:19], v[44:47], v[96:111]
    s_waitcnt lgkmcnt(0)
    s_add_u32 m0, s49, 4096
    s_add_u32 s64, s63, 2
    s_and_b32 s64, s64, 7
    s_add_u32 s64, s64, 24
    s_mul_i32 s64, s64, 44032
    s_add_u32 s64, s64, s57
    buffer_load_dwordx4 v4, s[28:31], s64 offen lds
    v_mfma_f32_32x32x16_bf16 v[112:127], v[16:19], v[48:51], v[112:127]
    s_add_u32 m0, s49, 5120
    s_nop 0
    buffer_load_dwordx4 v5, s[28:31], s64 offen lds
    s_waitcnt vmcnt(8)
    v_mfma_f32_32x32x16_bf16 v[64:79], v[20:23], v[52:55], v[64:79]
    ds_read_b64_tr_b16 v[12:13], v8 offset:0
    ds_read_b64_tr_b16 v[14:15], v8 offset:512
    ds_read_b64_tr_b16 v[16:17], v9 offset:0
    ds_read_b64_tr_b16 v[18:19], v9 offset:512
    s_add_u32 s65, s63, 2
    s_and_b32 s65, s65, 7
    s_add_u32 s65, s65, 24
    s_mul_i32 s65, s65, 16384
    s_add_u32 s65, s65, s58
    buffer_load_dwordx4 v[44:47], v6, s[32:35], s65 offen sc1
    v_mfma_f32_32x32x16_bf16 v[80:95], v[20:23], v[56:59], v[80:95]
    buffer_load_dwordx4 v[48:51], v7, s[32:35], s65 offen sc1
    v_mfma_f32_32x32x16_bf16 v[96:111], v[24:27], v[52:55], v[96:111]
    s_waitcnt lgkmcnt(0)
    s_add_u32 m0, s49, 0
    s_add_u32 s64, s63, 3
    s_and_b32 s64, s64, 7
    s_add_u32 s64, s64, 24
    s_mul_i32 s64, s64, 44032
    s_add_u32 s64, s64, s57
    buffer_load_dwordx4 v4, s[28:31], s64 offen lds
    v_mfma_f32_32x32x16_bf16 v[112:127], v[24:27], v[56:59], v[112:127]
    s_add_u32 m0, s49, 1024
    s_nop 0
    buffer_load_dwordx4 v5, s[28:31], s64 offen lds
    s_waitcnt vmcnt(8)
    v_mfma_f32_32x32x16_bf16 v[64:79], v[12:15], v[28:31], v[64:79]
    ds_read_b64_tr_b16 v[20:21], v8 offset:2048
    ds_read_b64_tr_b16 v[22:23], v8 offset:2560
    ds_read_b64_tr_b16 v[24:25], v9 offset:2048
    ds_read_b64_tr_b16 v[26:27], v9 offset:2560
    s_add_u32 s65, s63, 3
    s_and_b32 s65, s65, 7
    s_add_u32 s65, s65, 24
    s_mul_i32 s65, s65, 16384
    s_add_u32 s65, s65, s58
    buffer_load_dwordx4 v[52:55], v6, s[32:35], s65 offen sc1
    v_mfma_f32_32x32x16_bf16 v[80:95], v[12:15], v[32:35], v[80:95]
    buffer_load_dwordx4 v[56:59], v7, s[32:35], s65 offen sc1
    v_mfma_f32_32x32x16_bf16 v[96:111], v[16:19], v[28:31], v[96:111]
    s_waitcnt lgkmcnt(0)
    s_add_u32 m0, s49, 2048
    s_add_u32 s64, s63, 4
    s_and_b32 s64, s64, 7
    s_add_u32 s64, s64, 24
    s_mul_i32 s64, s64, 44032
    s_add_u32 s64, s64, s57
    buffer_load_dwordx4 v4, s[28:31], s64 offen lds
    v_mfma_f32_32x32x16_bf16 v[112:127], v[16:19], v[32:35], v[112:127]
    s_add_u32 m0, s49, 3072
    s_nop 0
    buffer_load_dwordx4 v5, s[28:31], s64 offen lds
    s_waitcnt vmcnt(8)
    v_mfma_f32_32x32x16_bf16 v[64:79], v[20:23], v[36:39], v[64:79]
    ds_read_b64_tr_b16 v[12:13], v8 offset:4096
    ds_read_b64_tr_b16 v[14:15], v8 offset:4608
    ds_read_b64_tr_b16 v[16:17], v9 offset:4096
    ds_read_b64_tr_b16 v[18:19], v9 offset:4608
    s_add_u32 s65, s63, 4
    s_and_b32 s65, s65, 7
    s_add_u32 s65, s65, 24
    s_mul_i32 s65, s65, 16384
    s_add_u32 s65, s65, s58
    buffer_load_dwordx4 v[28:31], v6, s[32:35], s65 offen sc1
    v_mfma_f32_32x32x16_bf16 v[80:95], v[20:23], v[40:43], v[80:95]
    buffer_load_dwordx4 v[32:35], v7, s[32:35], s65 offen sc1
    v_mfma_f32_32x32x16_bf16 v[96:111], v[24:27], v[36:39], v[96:111]
    s_waitcnt lgkmcnt(0)
    s_add_u32 m0, s49, 4096
    s_add_u32 s64, s63, 5
    s_and_b32 s64, s64, 7
    s_add_u32 s64, s64, 24
    s_mul_i32 s64, s64, 44032
    s_add_u32 s64, s64, s57
    buffer_load_dwordx4 v4, s[28:31], s64 offen lds
    v_mfma_f32_32x32x16_bf16 v[112:127], v[24:27], v[40:43], v[112:127]
    s_add_u32 m0, s49, 5120
    s_nop 0
    buffer_load_dwordx4 v5, s[28:31], s64 offen lds
    s_waitcnt vmcnt(8)
    v_mfma_f32_32x32x16_bf16 v[64:79], v[12:15], v[44:47], v[64:79]
    ds_read_b64_tr_b16 v[20:21], v8 offset:0
    ds_read_b64_tr_b16 v[22:23], v8 offset:512
    ds_read_b64_tr_b16 v[24:25], v9 offset:0
    ds_read_b64_tr_b16 v[26:27], v9 offset:512
    s_add_u32 s65, s63, 5
    s_and_b32 s65, s65, 7
    s_add_u32 s65, s65, 24
    s_mul_i32 s65, s65, 16384
    s_add_u32 s65, s65, s58
    buffer_load_dwordx4 v[36:39], v6, s[32:35], s65 offen sc1
    v_mfma_f32_32x32x16_bf16 v[80:95], v[12:15], v[48:51], v[80:95]
    buffer_load_dwordx4 v[40:43], v7, s[32:35], s65 offen sc1
    v_mfma_f32_32x32x16_bf16 v[96:111], v[16:19], v[44:47], v[96:111]
    s_waitcnt lgkmcnt(0)
    s_add_u32 m0, s49, 0
    s_add_u32 s64, s63, 6
    s_and_b32 s64, s64, 7
    s_add_u32 s64, s64, 24
    s_mul_i32 s64, s64, 44032
    s_add_u32 s64, s64, s57
    buffer_load_dwordx4 v4, s[28:31], s64 offen lds
    v_mfma_f32_32x32x16_bf16 v[112:127], v[16:19], v[48:51], v[112:127]
    s_add_u32 m0, s49, 1024
    s_nop 0
    buffer_load_dwordx4 v5, s[28:31], s64 offen lds
    s_waitcnt vmcnt(8)
    v_mfma_f32_32x32x16_bf16 v[64:79], v[20:23], v[52:55], v[64:79]
    ds_read_b64_tr_b16 v[12:13], v8 offset:2048
    ds_read_b64_tr_b16 v[14:15], v8 offset:2560
    ds_read_b64_tr_b16 v[16:17], v9 offset:2048
    ds_read_b64_tr_b16 v[18:19], v9 offset:2560
    s_add_u32 s65, s63, 6
    s_and_b32 s65, s65, 7
    s_add_u32 s65, s65, 24
    s_mul_i32 s65, s65, 16384
    s_add_u32 s65, s65, s58
    buffer_load_dwordx4 v[44:47], v6, s[32:35], s65 offen sc1
    v_mfma_f32_32x32x16_bf16 v[80:95], v[20:23], v[56:59], v[80:95]
    buffer_load_dwordx4 v[48:51], v7, s[32:35], s65 offen sc1
    v_mfma_f32_32x32x16_bf16 v[96:111], v[24:27], v[52:55], v[96:111]
    s_waitcnt lgkmcnt(0)
    s_add_u32 m0, s49, 2048
    s_add_u32 s64, s63, 7
    s_and_b32 s64, s64, 7
    s_add_u32 s64, s64, 24
    s_mul_i32 s64, s64, 44032
    s_add_u32 s64, s64, s57
    buffer_load_dwordx4 v4, s[28:31], s64 offen lds
    v_mfma_f32_32x32x16_bf16 v[112:127], v[24:27], v[56:59], v[112:127]
    s_add_u32 m0, s49, 3072
    s_nop 0
    buffer_load_dwordx4 v5, s[28:31], s64 offen lds
    s_waitcnt vmcnt(8)
    v_mfma_f32_32x32x16_bf16 v[64:79], v[12:15], v[28:31], v[64:79]
    ds_read_b64_tr_b16 v[20:21], v8 offset:4096
    ds_read_b64_tr_b16 v[22:23], v8 offset:4608
    ds_read_b64_tr_b16 v[24:25], v9 offset:4096
    ds_read_b64_tr_b16 v[26:27], v9 offset:4608
    s_add_u32 s65, s63, 7
    s_and_b32 s65, s65, 7
    s_add_u32 s65, s65, 24
    s_mul_i32 s65, s65, 16384
    s_add_u32 s65, s65, s58
    buffer_load_dwordx4 v[52:55], v6, s[32:35], s65 offen sc1
    v_mfma_f32_32x32x16_bf16 v[80:95], v[12:15], v[32:35], v[80:95]
    buffer_load_dwordx4 v[56:59], v7, s[32:35], s65 offen sc1
    v_mfma_f32_32x32x16_bf16 v[96:111], v[16:19], v[28:31], v[96:111]
    s_waitcnt lgkmcnt(0)
    v_mfma_f32_32x32x16_bf16 v[112:127], v[16:19], v[32:35], v[112:127]
    s_waitcnt vmcnt(6)
    v_mfma_f32_32x32x16_bf16 v[64:79], v[20:23], v[36:39], v[64:79]
    ds_read_b64_tr_b16 v[12:13], v8 offset:0
    ds_read_b64_tr_b16 v[14:15], v8 offset:512
    ds_read_b64_tr_b16 v[16:17], v9 offset:0
    ds_read_b64_tr_b16 v[18:19], v9 offset:512
    v_mfma_f32_32x32x16_bf16 v[80:95], v[20:23], v[40:43], v[80:95]
    v_mfma_f32_32x32x16_bf16 v[96:111], v[24:27], v[36:39], v[96:111]
    s_waitcnt lgkmcnt(0)
    v_mfma_f32_32x32x16_bf16 v[112:127], v[24:27], v[40:43], v[112:127]
    s_waitcnt vmcnt(2)
    v_mfma_f32_32x32x16_bf16 v[64:79], v[12:15], v[44:47], v[64:79]
    ds_read_b64_tr_b16 v[20:21], v8 offset:2048
    ds_read_b64_tr_b16 v[22:23], v8 offset:2560
    ds_read_b64_tr_b16 v[24:25], v9 offset:2048
    ds_read_b64_tr_b16 v[26:27], v9 offset:2560
    v_mfma_f32_32x32x16_bf16 v[80:95], v[12:15], v[48:51], v[80:95]
    v_mfma_f32_32x32x16_bf16 v[96:111], v[16:19], v[44:47], v[96:111]
    s_waitcnt lgkmcnt(0)
    v_mfma_f32_32x32x16_bf16 v[112:127], v[16:19], v[48:51], v[112:127]
    s_waitcnt vmcnt(0)
    v_mfma_f32_32x32x16_bf16 v[64:79], v[20:23], v[52:55], v[64:79]
    v_mfma_f32_32x32x16_bf16 v[80:95], v[20:23], v[56:59], v[80:95]
    v_mfma_f32_32x32x16_bf16 v[96:111], v[24:27], v[52:55], v[96:111]
    v_mfma_f32_32x32x16_bf16 v[112:127], v[24:27], v[56:59], v[112:127]
    s_setprio 3
    s_mov_b32 s28, s14
    s_mov_b32 s29, s15
    s_mov_b32 s30, 0xac0
    s_mov_b32 s31, 0x20000
    s_add_u32 s32, s26, 0x800000
    s_addc_u32 s33, s27, 0
    s_mov_b32 s34, 0x158000
    s_mov_b32 s35, 0x20000
    s_lshl_b32 s61, s56, 7
    s_add_u32 s61, s61, s60
    v_lshrrev_b32 v10, 5, v1
    v_lshlrev_b32 v10, 3, v10
    buffer_load_dwordx2 v[28:29], v10, s[28:31], s61 offen offset:0
    buffer_load_dwordx2 v[30:31], v10, s[28:31], s61 offen offset:16
    buffer_load_dwordx2 v[32:33], v10, s[28:31], s61 offen offset:32
    buffer_load_dwordx2 v[34:35], v10, s[28:31], s61 offen offset:48
    v_lshlrev_b32 v10, 4, v1
    v_add_u32 v10, s49, v10
    v_mov_b32 v11, s49
    v_mov_b32 v129, 1
    s_nop 7
    ds_write_b128 v10, v[80:83] offset:0
    ds_write_b128 v10, v[84:87] offset:1024
    ds_write_b128 v10, v[88:91] offset:2048
    ds_write_b128 v10, v[92:95] offset:3072
    v_xor_b32 v131, 8192, v11
    s_waitcnt lgkmcnt(0)
    ds_write_b32 v11, v129 offset:6144
    s_mov_b32 s62, 0x100000
M1_R1:
    ds_read_b32 v128, v131 offset:6144
    s_waitcnt lgkmcnt(0)
    v_cmp_ne_u32 vcc, 1, v128
    s_sub_u32 s62, s62, 1
    s_cbranch_scc1 M1_R1_X
    s_cbranch_vccz M1_R1_X
    s_sleep 1
    s_branch M1_R1
M1_R1_X:
    v_xor_b32 v130, 8192, v10
    ds_read_b128 v[44:47], v130 offset:0
    ds_read_b128 v[48:51], v130 offset:1024
    ds_read_b128 v[52:55], v130 offset:2048
    ds_read_b128 v[56:59], v130 offset:3072
    s_waitcnt lgkmcnt(0)
    v_xor_b32 v130, 8192, v10
    ds_write_b128 v130, v[96:99] offset:0
    ds_write_b128 v130, v[100:103] offset:1024
    ds_write_b128 v130, v[104:107] offset:2048
    ds_write_b128 v130, v[108:111] offset:3072
    v_xor_b32 v131, 16384, v11
    v_pk_add_f32 v[64:65], v[64:65], v[44:45]
    v_pk_add_f32 v[66:67], v[66:67], v[46:47]
    v_pk_add_f32 v[68:69], v[68:69], v[48:49]
    v_pk_add_f32 v[70:71], v[70:71], v[50:51]
    v_pk_add_f32 v[72:73], v[72:73], v[52:53]
    v_pk_add_f32 v[74:75], v[74:75], v[54:55]
    v_pk_add_f32 v[76:77], v[76:77], v[56:57]
    v_pk_add_f32 v[78:79], v[78:79], v[58:59]
    s_waitcnt lgkmcnt(0)
    ds_write_b32 v11, v129 offset:6148
    s_mov_b32 s62, 0x100000
M1_R2:
    ds_read_b32 v128, v131 offset:6148
    s_waitcnt lgkmcnt(0)
    v_cmp_ne_u32 vcc, 1, v128
    s_sub_u32 s62, s62, 1
    s_cbranch_scc1 M1_R2_X
    s_cbranch_vccz M1_R2_X
    s_sleep 1
    s_branch M1_R2
M1_R2_X:
    v_xor_b32 v130, 24576, v10
    ds_read_b128 v[44:47], v130 offset:0
    ds_read_b128 v[48:51], v130 offset:1024
    ds_read_b128 v[52:55], v130 offset:2048
    ds_read_b128 v[56:59], v130 offset:3072
    s_waitcnt lgkmcnt(0)
    v_xor_b32 v130, 24576, v10
    ds_write_b128 v130, v[112:115] offset:0
    ds_write_b128 v130, v[116:119] offset:1024
    ds_write_b128 v130, v[120:123] offset:2048
    ds_write_b128 v130, v[124:127] offset:3072
    v_xor_b32 v131, 24576, v11
    v_pk_add_f32 v[64:65], v[64:65], v[44:45]
    v_pk_add_f32 v[66:67], v[66:67], v[46:47]
    v_pk_add_f32 v[68:69], v[68:69], v[48:49]
    v_pk_add_f32 v[70:71], v[70:71], v[50:51]
    v_pk_add_f32 v[72:73], v[72:73], v[52:53]
    v_pk_add_f32 v[74:75], v[74:75], v[54:55]
    v_pk_add_f32 v[76:77], v[76:77], v[56:57]
    v_pk_add_f32 v[78:79], v[78:79], v[58:59]
    s_waitcnt lgkmcnt(0)
    ds_write_b32 v11, v129 offset:6152
    s_mov_b32 s62, 0x100000
M1_R3:
    ds_read_b32 v128, v131 offset:6152
    s_waitcnt lgkmcnt(0)
    v_cmp_ne_u32 vcc, 1, v128
    s_sub_u32 s62, s62, 1
    s_cbranch_scc1 M1_R3_X
    s_cbranch_vccz M1_R3_X
    s_sleep 1
    s_branch M1_R3
M1_R3_X:
    ds_read_b128 v[44:47], v10 offset:0
    ds_read_b128 v[48:51], v10 offset:1024
    ds_read_b128 v[52:55], v10 offset:2048
    ds_read_b128 v[56:59], v10 offset:3072
    s_waitcnt lgkmcnt(0)
    v_pk_add_f32 v[64:65], v[64:65], v[44:45]
    v_pk_add_f32 v[66:67], v[66:67], v[46:47]
    v_pk_add_f32 v[68:69], v[68:69], v[48:49]
    v_pk_add_f32 v[70:71], v[70:71], v[50:51]
    v_pk_add_f32 v[72:73], v[72:73], v[52:53]
    v_pk_add_f32 v[74:75], v[74:75], v[54:55]
    v_pk_add_f32 v[76:77], v[76:77], v[56:57]
    v_pk_add_f32 v[78:79], v[78:79], v[58:59]
    s_mov_b32 s61, 0xffff0000
    s_waitcnt vmcnt(0)
    v_lshlrev_b32 v80, 16, v28
    v_and_b32 v81, s61, v28
    v_lshlrev_b32 v82, 16, v29
    v_and_b32 v83, s61, v29
    v_lshlrev_b32 v84, 16, v30
    v_and_b32 v85, s61, v30
    v_lshlrev_b32 v86, 16, v31
    v_and_b32 v87, s61, v31
    v_lshlrev_b32 v88, 16, v32
    v_and_b32 v89, s61, v32
    v_lshlrev_b32 v90, 16, v33
    v_and_b32 v91, s61, v33
    v_lshlrev_b32 v92, 16, v34
    v_and_b32 v93, s61, v34
    v_lshlrev_b32 v94, 16, v35
    v_and_b32 v95, s61, v35
    v_pk_add_f32 v[64:65], v[64:65], v[80:81]
    v_pk_add_f32 v[66:67], v[66:67], v[82:83]
    v_pk_add_f32 v[68:69], v[68:69], v[84:85]
    v_pk_add_f32 v[70:71], v[70:71], v[86:87]
    v_pk_add_f32 v[72:73], v[72:73], v[88:89]
    v_pk_add_f32 v[74:75], v[74:75], v[90:91]
    v_pk_add_f32 v[76:77], v[76:77], v[92:93]
    v_pk_add_f32 v[78:79], v[78:79], v[94:95]
    v_mov_b32 v96, 0xc0135761
    v_mov_b32 v97, 0xc0135761
    v_mov_b32 v98, 0xbdd2d3e8
    v_mov_b32 v99, 0xbdd2d3e8
    v_mov_b32 v100, 1.0
    v_mov_b32 v101, 1.0
    v_pk_mul_f32 v[80:81], v[64:65], v[64:65]
    v_pk_mul_f32 v[82:83], v[66:67], v[66:67]
    v_pk_mul_f32 v[84:85], v[68:69], v[68:69]
    v_pk_mul_f32 v[86:87], v[70:71], v[70:71]
    v_pk_mul_f32 v[88:89], v[72:73], v[72:73]
    v_pk_mul_f32 v[90:91], v[74:75], v[74:75]
    v_pk_mul_f32 v[92:93], v[76:77], v[76:77]
    v_pk_mul_f32 v[94:95], v[78:79], v[78:79]
    v_pk_fma_f32 v[80:81], v[80:81], v[98:99], v[96:97]
    v_pk_fma_f32 v[82:83], v[82:83], v[98:99], v[96:97]
    v_pk_fma_f32 v[84:85], v[84:85], v[98:99], v[96:97]
    v_pk_fma_f32 v[86:87], v[86:87], v[98:99], v[96:97]
    v_pk_fma_f32 v[88:89], v[88:89], v[98:99], v[96:97]
    v_pk_fma_f32 v[90:91], v[90:91], v[98:99], v[96:97]
    v_pk_fma_f32 v[92:93], v[92:93], v[98:99], v[96:97]
    v_pk_fma_f32 v[94:95], v[94:95], v[98:99], v[96:97]
    v_pk_mul_f32 v[80:81], v[80:81], v[64:65]
    v_pk_mul_f32 v[82:83], v[82:83], v[66:67]
    v_pk_mul_f32 v[84:85], v[84:85], v[68:69]
    v_pk_mul_f32 v[86:87], v[86:87], v[70:71]
    v_pk_mul_f32 v[88:89], v[88:89], v[72:73]
    v_pk_mul_f32 v[90:91], v[90:91], v[74:75]
    v_pk_mul_f32 v[92:93], v[92:93], v[76:77]
    v_pk_mul_f32 v[94:95], v[94:95], v[78:79]
    v_exp_f32 v80, v80
    v_exp_f32 v81, v81
    v_exp_f32 v82, v82
    v_exp_f32 v83, v83
    v_exp_f32 v84, v84
    v_exp_f32 v85, v85
    v_exp_f32 v86, v86
    v_exp_f32 v87, v87
    v_exp_f32 v88, v88
    v_exp_f32 v89, v89
    v_exp_f32 v90, v90
    v_exp_f32 v91, v91
    v_exp_f32 v92, v92
    v_exp_f32 v93, v93
    v_exp_f32 v94, v94
    v_exp_f32 v95, v95
    v_pk_add_f32 v[80:81], v[80:81], v[100:101]
    v_pk_add_f32 v[82:83], v[82:83], v[100:101]
    v_pk_add_f32 v[84:85], v[84:85], v[100:101]
    v_pk_add_f32 v[86:87], v[86:87], v[100:101]
    v_pk_add_f32 v[88:89], v[88:89], v[100:101]
    v_pk_add_f32 v[90:91], v[90:91], v[100:101]
    v_pk_add_f32 v[92:93], v[92:93], v[100:101]
    v_pk_add_f32 v[94:95], v[94:95], v[100:101]
    v_rcp_f32 v80, v80
    v_rcp_f32 v81, v81
    v_rcp_f32 v82, v82
    v_rcp_f32 v83, v83
    v_rcp_f32 v84, v84
    v_rcp_f32 v85, v85
    v_rcp_f32 v86, v86
    v_rcp_f32 v87, v87
    v_rcp_f32 v88, v88
    v_rcp_f32 v89, v89
    v_rcp_f32 v90, v90
    v_rcp_f32 v91, v91
    v_rcp_f32 v92, v92
    v_rcp_f32 v93, v93
    v_rcp_f32 v94, v94
    v_rcp_f32 v95, v95
    v_pk_mul_f32 v[64:65], v[64:65], v[80:81]
    v_pk_mul_f32 v[66:67], v[66:67], v[82:83]
    v_pk_mul_f32 v[68:69], v[68:69], v[84:85]
    v_pk_mul_f32 v[70:71], v[70:71], v[86:87]
    v_pk_mul_f32 v[72:73], v[72:73], v[88:89]
    v_pk_mul_f32 v[74:75], v[74:75], v[90:91]
    v_pk_mul_f32 v[76:77], v[76:77], v[92:93]
    v_pk_mul_f32 v[78:79], v[78:79], v[94:95]
    v_cvt_pk_bf16_f32 v12, v64, v65
    v_cvt_pk_bf16_f32 v13, v66, v67
    v_cvt_pk_bf16_f32 v14, v68, v69
    v_cvt_pk_bf16_f32 v15, v70, v71
    v_cvt_pk_bf16_f32 v16, v72, v73
    v_cvt_pk_bf16_f32 v17, v74, v75
    v_cvt_pk_bf16_f32 v18, v76, v77
    v_cvt_pk_bf16_f32 v19, v78, v79
    s_lshl_b32 s61, s56, 16
    s_lshl_b32 s62, s51, 15
    s_add_u32 s61, s61, s62
    s_add_u32 s61, s61, s59
    s_add_u32 s62, s61, 16384
    buffer_store_dwordx4 v[12:15], v6, s[32:35], s61 offen sc1
    buffer_store_dwordx4 v[16:19], v6, s[32:35], s62 offen sc1
    s_lshl_b32 s61, s56, 2
    s_add_u32 s61, s61, s48
    s_lshl_b32 s61, s61, 3
    s_add_u32 s61, s61, s59
    s_lshl_b32 s61, s61, 4
    s_add_u32 s61, s61, 262144
    v_lshlrev_b32 v10, 20, v1
    s_waitcnt vmcnt(0)
    buffer_store_dwordx2 v[166:167], v10, s[36:39], s61 offen sc1
    s_branch M_2
M_SVC:
    s_and_b32 s57, s53, 7
    s_lshl_b32 s58, s48, 5
    s_add_u32 s57, s57, s58
    s_sub_u32 s58, s56, s55
    s_lshl_b32 s58, s58, 7
    s_mul_i32 s59, s57, 44032
    s_add_u32 s58, s58, s59
    s_lshl_b32 s59, s57, 14
    s_and_b32 s60, s52, 1
    s_lshl_b32 s60, s60, 12
    s_add_u32 s59, s59, s60
    v_lshrrev_b32 v4, 3, v1
    v_mul_u32_u24 v4, 2752, v4
    v_and_b32 v5, 7, v1
    v_min_u32 v5, 6, v5
    v_lshl_add_u32 v4, v5, 7, v4
    v_add_u32 v5, 22016, v4
    v_lshrrev_b32 v6, 5, v1
    v_lshlrev_b32 v6, 13, v6
    v_and_b32 v7, 31, v1
    v_lshl_add_u32 v6, v7, 7, v6
    s_barrier
    s_barrier
    buffer_load_dword v12, v4, s[28:31], s58 offen
    buffer_load_dword v13, v5, s[28:31], s58 offen
    s_add_u32 s58, s58, 352256
    s_waitcnt vmcnt(0)
    ds_write_b32 v136, v137 offset:16
M_IDLE:
    v_and_b32 v132, 7, v1
    v_lshlrev_b32 v132, 2, v132
    v_add_u32 v132, 137312, v132
    s_mov_b32 s62, 0x100000
M_KV2D:
    ds_read_b32 v128, v132 offset:0
    s_waitcnt lgkmcnt(0)
    v_cmp_ne_u32 vcc, 1, v128
    s_sub_u32 s62, s62, 1
    s_cbranch_scc1 M_KV2D_X
    s_cbranch_vccz M_KV2D_X
    s_sleep 2
    s_branch M_KV2D
M_KV2D_X:
    s_lshl_b32 s44, s52, 5
    s_add_u32 s44, s44, s48
    s_lshl_b32 s44, s44, 7
    s_add_u32 s44, s44, 163840
    v_and_b32 v132, 7, v1
    v_lshlrev_b32 v132, 9, v132
    v_bfe_u32 v133, v1, 3, 1
    v_lshl_add_u32 v132, v133, 15, v132
    s_mov_b32 s62, 0x40000
M_KV2C:
    buffer_load_dwordx2 v[128:129], v132, s[36:39], s44 offen sc1
    s_waitcnt vmcnt(0)
    v_xor_b32 v128, v128, v166
    v_xor_b32 v129, v129, v167
    v_or_b32 v128, v128, v129
    v_cmp_ne_u32 vcc, 0, v128
    s_sub_u32 s62, s62, 1
    s_cbranch_scc1 M_KV2C_X
    s_cbranch_vccz M_KV2C_X
    s_sleep 2
    s_branch M_KV2C
M_KV2C_X:
    s_lshl_b32 s44, s52, 2
    s_and_b32 s45, s53, 3
    s_add_u32 s44, s44, s45
    s_lshl_b32 s44, s44, 17
    s_lshl_b32 s46, s48, 12
    s_lshr_b32 s45, s53, 2
    s_min_u32 s45, s45, 4
    s_add_u32 s45, s45, 2
    s_lshl_b32 s45, s45, 14
    s_add_u32 s45, s45, 16384
    s_cmp_ge_u32 s45, 0x20000
    s_cselect_b32 s45, 49152, s45
    s_add_u32 s47, s45, s46
    s_mov_b32 m0, s47
    s_add_u32 s47, s47, s44
    buffer_load_dwordx4 v2, s[40:43], s47 offen offset:0 sc1 lds
    buffer_load_dwordx4 v2, s[40:43], s47 offen offset:1024 sc1 lds
    buffer_load_dwordx4 v2, s[40:43], s47 offen offset:2048 sc1 lds
    buffer_load_dwordx4 v2, s[40:43], s47 offen offset:3072 sc1 lds
    s_add_u32 s45, s45, 16384
    s_cmp_ge_u32 s45, 0x20000
    s_cselect_b32 s45, 49152, s45
    s_add_u32 s47, s45, s46
    s_mov_b32 m0, s47
    s_add_u32 s47, s47, s44
    buffer_load_dwordx4 v2, s[40:43], s47 offen offset:0 sc1 lds
    buffer_load_dwordx4 v2, s[40:43], s47 offen offset:1024 sc1 lds
    buffer_load_dwordx4 v2, s[40:43], s47 offen offset:2048 sc1 lds
    buffer_load_dwordx4 v2, s[40:43], s47 offen offset:3072 sc1 lds
    s_add_u32 s45, s45, 16384
    s_cmp_ge_u32 s45, 0x20000
    s_cselect_b32 s45, 49152, s45
    s_add_u32 s47, s45, s46
    s_mov_b32 m0, s47
    s_add_u32 s47, s47, s44
    buffer_load_dwordx4 v2, s[40:43], s47 offen offset:0 sc1 lds
    buffer_load_dwordx4 v2, s[40:43], s47 offen offset:1024 sc1 lds
    buffer_load_dwordx4 v2, s[40:43], s47 offen offset:2048 sc1 lds
    buffer_load_dwordx4 v2, s[40:43], s47 offen offset:3072 sc1 lds
    s_add_u32 s45, s45, 16384
    s_cmp_ge_u32 s45, 0x20000
    s_cselect_b32 s45, 49152, s45
    s_add_u32 s47, s45, s46
    s_mov_b32 m0, s47
    s_add_u32 s47, s47, s44
    buffer_load_dwordx4 v2, s[40:43], s47 offen offset:0 sc1 lds
    buffer_load_dwordx4 v2, s[40:43], s47 offen offset:1024 sc1 lds
    buffer_load_dwordx4 v2, s[40:43], s47 offen offset:2048 sc1 lds
    buffer_load_dwordx4 v2, s[40:43], s47 offen offset:3072 sc1 lds
    s_add_u32 s45, s45, 16384
    s_cmp_ge_u32 s45, 0x20000
    s_cselect_b32 s45, 49152, s45
    s_add_u32 s47, s45, s46
    s_mov_b32 m0, s47
    s_add_u32 s47, s47, s44
    buffer_load_dwordx4 v2, s[40:43], s47 offen offset:0 sc1 lds
    buffer_load_dwordx4 v2, s[40:43], s47 offen offset:1024 sc1 lds
    buffer_load_dwordx4 v2, s[40:43], s47 offen offset:2048 sc1 lds
    buffer_load_dwordx4 v2, s[40:43], s47 offen offset:3072 sc1 lds
    s_waitcnt vmcnt(0)
    ds_write_b32 v136, v137
    s_cmp_lt_u32 s53, 24
    s_cbranch_scc1 M_IDLE2
    s_lshl_b32 s61, s48, 11
    v_and_b32 v10, 15, v1
    v_lshlrev_b32 v10, 7, v10
    s_mov_b32 s62, 0x40000
M_HT2:
    buffer_load_dwordx2 v[128:129], v10, s[36:39], s61 offen sc1
    s_waitcnt vmcnt(0)
    v_xor_b32 v128, v128, v166
    v_xor_b32 v129, v129, v167
    v_or_b32 v128, v128, v129
    v_cmp_ne_u32 vcc, 0, v128
    s_sub_u32 s62, s62, 1
    s_cbranch_scc1 M_HT2_X
    s_cbranch_vccz M_HT2_X
    s_sleep 4
    s_branch M_HT2
M_HT2_X:
    buffer_load_dword v14, v6, s[32:35], s59 offen sc1
    s_add_u32 s59, s59, 131072
    buffer_load_dword v15, v4, s[28:31], s58 offen
    buffer_load_dword v16, v5, s[28:31], s58 offen
    s_add_u32 s58, s58, 352256
    buffer_load_dword v17, v6, s[32:35], s59 offen sc1
    s_add_u32 s59, s59, 131072
    buffer_load_dword v18, v4, s[28:31], s58 offen
    buffer_load_dword v19, v5, s[28:31], s58 offen
    s_add_u32 s58, s58, 352256
    buffer_load_dword v20, v6, s[32:35], s59 offen sc1
    s_add_u32 s59, s59, 131072
    buffer_load_dword v21, v4, s[28:31], s58 offen
    buffer_load_dword v22, v5, s[28:31], s58 offen
    s_add_u32 s58, s58, 352256
    buffer_load_dword v23, v6, s[32:35], s59 offen sc1
    s_add_u32 s59, s59, 131072
    s_mov_b32 s28, s16
    s_mov_b32 s29, s17
    s_mov_b32 s30, 0x560000
    s_mov_b32 s31, 0x20000
    s_and_b32 s57, s53, 7
    s_lshl_b32 s57, s57, 2
    s_add_u32 s57, s57, s48
    s_mul_i32 s58, s57, 176128
    s_lshl_b32 s59, s52, 9
    s_add_u32 s58, s58, s59
    v_lshrrev_b32 v10, 2, v1
    v_lshlrev_b32 v10, 12, v10
    v_and_b32 v11, 3, v1
    v_lshl_add_u32 v10, v11, 7, v10
    buffer_load_dword v24, v10, s[28:31], s58 offen
    s_add_u32 s58, s58, 65536
    buffer_load_dword v25, v10, s[28:31], s58 offen
    s_add_u32 s58, s58, 65536
    buffer_load_dword v26, v10, s[28:31], s58 offen
    s_add_u32 s58, s58, 65536
    s_mov_b32 s28, s8
    s_mov_b32 s29, s9
    s_mov_b32 s30, 0x80000
    s_mov_b32 s31, 0x20000
    s_lshl_b32 s58, s57, 14
    v_lshlrev_b32 v10, 7, v1
    buffer_load_dword v27, v10, s[28:31], s58 offen
    s_add_u32 s58, s58, 8192
    buffer_load_dword v23, v10, s[28:31], s58 offen
    s_waitcnt vmcnt(0)
M_IDLE2:
    s_add_u32 s32, s26, 0x800000
    s_addc_u32 s33, s27, 0
    s_mov_b32 s34, 0x158000
    s_mov_b32 s35, 0x20000
M_2:
    s_mov_b32 s28, s16
    s_mov_b32 s29, s17
    s_mov_b32 s30, 0x560000
    s_mov_b32 s31, 0x20000
    s_and_b32 s54, s53, 7
    s_lshr_b32 s55, s53, 3
    s_lshl_b32 s56, s52, 2
    s_add_u32 s56, s56, s55
    s_mul_i32 s57, s48, 1441792
    s_lshl_b32 s58, s56, 7
    s_add_u32 s57, s57, s58
    s_mul_i32 s58, s48, 360448
    s_lshl_b32 s59, s54, 10
    s_add_u32 s58, s58, s59
    s_lshl_b32 s60, s50, 6
    s_lshl_b32 s61, s51, 9
    v_lshrrev_b32 v10, 3, v1
    v_mul_u32_u24 v10, 4096, v10
    v_bfe_u32 v11, v1, 4, 1
    v_lshlrev_b32 v11, 2, v11
    v_xor_b32 v11, v11, v1
    v_and_b32 v11, 7, v11
    v_lshl_add_u32 v4, v11, 4, v10
    v_add_u32 v5, 32768, v4
    v_xor_b32 v6, s61, v3
    v_xor_b32 v7, 512, v6
    s_add_u32 s63, s55, s54
    s_add_u32 m0, s49, 0
    s_add_u32 s64, s63, 0
    s_and_b32 s64, s64, 3
    s_add_u32 s64, s64, 0
    s_mul_i32 s64, s64, 65536
    s_add_u32 s64, s64, s57
    buffer_load_dwordx4 v4, s[28:31], s64 offen lds
    s_add_u32 m0, s49, 1024
    s_nop 0
    buffer_load_dwordx4 v5, s[28:31], s64 offen lds
    s_add_u32 m0, s49, 2048
    s_add_u32 s64, s63, 1
    s_and_b32 s64, s64, 3
    s_add_u32 s64, s64, 0
    s_mul_i32 s64, s64, 65536
    s_add_u32 s64, s64, s57
    buffer_load_dwordx4 v4, s[28:31], s64 offen lds
    s_add_u32 m0, s49, 3072
    s_nop 0
    buffer_load_dwordx4 v5, s[28:31], s64 offen lds
    s_add_u32 m0, s49, 4096
    s_add_u32 s64, s63, 2
    s_and_b32 s64, s64, 3
    s_add_u32 s64, s64, 0
    s_mul_i32 s64, s64, 65536
    s_add_u32 s64, s64, s57
    buffer_load_dwordx4 v4, s[28:31], s64 offen lds
    s_add_u32 m0, s49, 5120
    s_nop 0
    buffer_load_dwordx4 v5, s[28:31], s64 offen lds
    v_lshrrev_b32 v10, 5, v1
    v_mul_u32_u24 v10, 4, v10
    v_bfe_u32 v11, v1, 2, 2
    v_add_u32 v10, v10, v11
    v_lshlrev_b32 v10, 7, v10
    v_bfe_u32 v11, v1, 3, 1
    v_lshl_add_u32 v10, v11, 6, v10
    v_bfe_u32 v11, v1, 4, 1
    v_lshl_add_u32 v10, v11, 5, v10
    v_and_b32 v11, 3, v1
    v_lshl_add_u32 v10, v11, 3, v10
    v_xor_b32 v10, s60, v10
    v_add_u32 v8, s49, v10
    v_xor_b32 v10, 64, v10
    v_add_u32 v9, s49, v10
    s_lshl_b32 s61, s2, 4
    s_add_u32 s61, s61, s48
    s_cmp_lg_u32 s61, 0
    s_cbranch_scc1 M_NOE
    v_lshrrev_b32 v10, 4, v1
    v_lshlrev_b32 v10, 13, v10
    v_and_b32 v11, 15, v1
    v_lshl_add_u32 v10, v11, 8, v10
    s_mov_b32 s61, 131072
    s_mov_b32 s62, 0x40000
M_E0:
    buffer_load_dwordx2 v[128:129], v10, s[36:39], s61 offen sc1
    s_waitcnt vmcnt(0)
    v_xor_b32 v128, v128, v166
    v_xor_b32 v129, v129, v167
    v_or_b32 v128, v128, v129
    v_cmp_ne_u32 vcc, 0, v128
    s_sub_u32 s62, s62, 1
    s_cbranch_scc1 M_E0_X
    s_cbranch_vccz M_E0_X
    s_sleep 8
    s_branch M_E0
M_E0_X:
    s_mov_b32 s61, 163840
    s_mov_b32 s62, 0x40000
M_E1:
    buffer_load_dwordx2 v[128:129], v10, s[36:39], s61 offen sc1
    s_waitcnt vmcnt(0)
    v_xor_b32 v128, v128, v166
    v_xor_b32 v129, v129, v167
    v_or_b32 v128, v128, v129
    v_cmp_ne_u32 vcc, 0, v128
    s_sub_u32 s62, s62, 1
    s_cbranch_scc1 M_E1_X
    s_cbranch_vccz M_E1_X
    s_sleep 8
    s_branch M_E1
M_E1_X:
    s_mov_b32 s61, 196608
    s_mov_b32 s62, 0x40000
M_E2:
    buffer_load_dwordx2 v[128:129], v10, s[36:39], s61 offen sc1
    s_waitcnt vmcnt(0)
    v_xor_b32 v128, v128, v166
    v_xor_b32 v129, v129, v167
    v_or_b32 v128, v128, v129
    v_cmp_ne_u32 vcc, 0, v128
    s_sub_u32 s62, s62, 1
    s_cbranch_scc1 M_E2_X
    s_cbranch_vccz M_E2_X
    s_sleep 8
    s_branch M_E2
M_E2_X:
    v_lshlrev_b32 v10, 7, v1
    s_mov_b32 s62, 0x40000
M_E3:
    buffer_load_dwordx2 v[128:129], v10, s[36:39], 0 offen sc1
    s_waitcnt vmcnt(0)
    v_xor_b32 v128, v128, v166
    v_xor_b32 v129, v129, v167
    v_or_b32 v128, v128, v129
    v_cmp_ne_u32 vcc, 0, v128
    s_sub_u32 s62, s62, 1
    s_cbranch_scc1 M_E3_X
    s_cbranch_vccz M_E3_X
    s_sleep 8
    s_branch M_E3
M_E3_X:
    v_lshlrev_b32 v10, 20, v1
    s_mov_b32 s61, 8192
    buffer_store_dwordx2 v[166:167], v10, s[36:39], s61 offen sc1
M_NOE:
    s_mul_i32 s61, s48, 11
    s_lshr_b32 s61, s61, 1
    s_lshl_b32 s61, s61, 5
    s_add_u32 s61, s61, s59
    s_lshl_b32 s61, s61, 4
    s_add_u32 s61, s61, 262144
    v_min_u32 v10, 23, v1
    v_lshlrev_b32 v10, 7, v10
    s_mov_b32 s62, 0x40000
M_U:
    buffer_load_dwordx2 v[128:129], v10, s[36:39], s61 offen sc1
    s_waitcnt vmcnt(0)
    v_xor_b32 v128, v128, v166
    v_xor_b32 v129, v129, v167
    v_or_b32 v128, v128, v129
    v_cmp_ne_u32 vcc, 0, v128
    s_sub_u32 s62, s62, 1
    s_cbranch_scc1 M_U_X
    s_cbranch_vccz M_U_X
    s_sleep 8
    s_branch M_U
M_U_X:
    s_add_u32 s65, s63, 0
    s_and_b32 s65, s65, 3
    s_add_u32 s65, s65, 0
    s_mul_i32 s65, s65, 16384
    s_add_u32 s65, s65, s58
    buffer_load_dwordx4 v[28:31], v6, s[32:35], s65 offen sc1
    buffer_load_dwordx4 v[32:35], v7, s[32:35], s65 offen sc1
    s_add_u32 s65, s63, 1
    s_and_b32 s65, s65, 3
    s_add_u32 s65, s65, 0
    s_mul_i32 s65, s65, 16384
    s_add_u32 s65, s65, s58
    buffer_load_dwordx4 v[36:39], v6, s[32:35], s65 offen sc1
    buffer_load_dwordx4 v[40:43], v7, s[32:35], s65 offen sc1
    s_add_u32 s65, s63, 2
    s_and_b32 s65, s65, 3
    s_add_u32 s65, s65, 0
    s_mul_i32 s65, s65, 16384
    s_add_u32 s65, s65, s58
    buffer_load_dwordx4 v[44:47], v6, s[32:35], s65 offen sc1
    buffer_load_dwordx4 v[48:51], v7, s[32:35], s65 offen sc1
    s_waitcnt vmcnt(10)
    ds_read_b64_tr_b16 v[12:13], v8 offset:0
    ds_read_b64_tr_b16 v[14:15], v8 offset:1024
    ds_read_b64_tr_b16 v[16:17], v9 offset:0
    ds_read_b64_tr_b16 v[18:19], v9 offset:1024
    s_waitcnt lgkmcnt(0)
    s_add_u32 m0, s49, 0
    s_add_u32 s64, s63, 3
    s_and_b32 s64, s64, 3
    s_add_u32 s64, s64, 0
    s_mul_i32 s64, s64, 65536
    s_add_u32 s64, s64, s57
    buffer_load_dwordx4 v4, s[28:31], s64 offen lds
    s_add_u32 m0, s49, 1024
    s_nop 0
    buffer_load_dwordx4 v5, s[28:31], s64 offen lds
    s_setprio 0
    s_waitcnt vmcnt(6)
    v_mfma_f32_32x32x16_bf16 v[64:79], v[28:31], v[12:15], 0
    ds_read_b64_tr_b16 v[20:21], v8 offset:2048
    ds_read_b64_tr_b16 v[22:23], v8 offset:3072
    ds_read_b64_tr_b16 v[24:25], v9 offset:2048
    ds_read_b64_tr_b16 v[26:27], v9 offset:3072
    s_add_u32 s65, s63, 3
    s_and_b32 s65, s65, 3
    s_add_u32 s65, s65, 0
    s_mul_i32 s65, s65, 16384
    s_add_u32 s65, s65, s58
    buffer_load_dwordx4 v[52:55], v6, s[32:35], s65 offen sc1
    v_mfma_f32_32x32x16_bf16 v[80:95], v[28:31], v[16:19], 0
    buffer_load_dwordx4 v[56:59], v7, s[32:35], s65 offen sc1
    v_mfma_f32_32x32x16_bf16 v[96:111], v[32:35], v[12:15], 0
    s_waitcnt lgkmcnt(0)
    s_add_u32 m0, s49, 2048
    s_add_u32 s64, s63, 0
    s_and_b32 s64, s64, 3
    s_add_u32 s64, s64, 4
    s_mul_i32 s64, s64, 65536
    s_add_u32 s64, s64, s57
    buffer_load_dwordx4 v4, s[28:31], s64 offen lds
    v_mfma_f32_32x32x16_bf16 v[112:127], v[32:35], v[16:19], 0
    s_add_u32 m0, s49, 3072
    s_nop 0
    buffer_load_dwordx4 v5, s[28:31], s64 offen lds
    s_waitcnt vmcnt(8)
    v_mfma_f32_32x32x16_bf16 v[64:79], v[36:39], v[20:23], v[64:79]
    ds_read_b64_tr_b16 v[12:13], v8 offset:4096
    ds_read_b64_tr_b16 v[14:15], v8 offset:5120
    ds_read_b64_tr_b16 v[16:17], v9 offset:4096
    ds_read_b64_tr_b16 v[18:19], v9 offset:5120
    s_add_u32 s65, s63, 0
    s_and_b32 s65, s65, 3
    s_add_u32 s65, s65, 4
    s_mul_i32 s65, s65, 16384
    s_add_u32 s65, s65, s58
    buffer_load_dwordx4 v[28:31], v6, s[32:35], s65 offen sc1
    v_mfma_f32_32x32x16_bf16 v[80:95], v[36:39], v[24:27], v[80:95]
    buffer_load_dwordx4 v[32:35], v7, s[32:35], s65 offen sc1
    v_mfma_f32_32x32x16_bf16 v[96:111], v[40:43], v[20:23], v[96:111]
    s_waitcnt lgkmcnt(0)
    s_add_u32 m0, s49, 4096
    s_add_u32 s64, s63, 1
    s_and_b32 s64, s64, 3
    s_add_u32 s64, s64, 4
    s_mul_i32 s64, s64, 65536
    s_add_u32 s64, s64, s57
    buffer_load_dwordx4 v4, s[28:31], s64 offen lds
    v_mfma_f32_32x32x16_bf16 v[112:127], v[40:43], v[24:27], v[112:127]
    s_add_u32 m0, s49, 5120
    s_nop 0
    buffer_load_dwordx4 v5, s[28:31], s64 offen lds
    s_waitcnt vmcnt(8)
    v_mfma_f32_32x32x16_bf16 v[64:79], v[44:47], v[12:15], v[64:79]
    ds_read_b64_tr_b16 v[20:21], v8 offset:0
    ds_read_b64_tr_b16 v[22:23], v8 offset:1024
    ds_read_b64_tr_b16 v[24:25], v9 offset:0
    ds_read_b64_tr_b16 v[26:27], v9 offset:1024
    s_add_u32 s65, s63, 1
    s_and_b32 s65, s65, 3
    s_add_u32 s65, s65, 4
    s_mul_i32 s65, s65, 16384
    s_add_u32 s65, s65, s58
    buffer_load_dwordx4 v[36:39], v6, s[32:35], s65 offen sc1
    v_mfma_f32_32x32x16_bf16 v[80:95], v[44:47], v[16:19], v[80:95]
    buffer_load_dwordx4 v[40:43], v7, s[32:35], s65 offen sc1
    v_mfma_f32_32x32x16_bf16 v[96:111], v[48:51], v[12:15], v[96:111]
    s_waitcnt lgkmcnt(0)
    s_add_u32 m0, s49, 0
    s_add_u32 s64, s63, 2
    s_and_b32 s64, s64, 3
    s_add_u32 s64, s64, 4
    s_mul_i32 s64, s64, 65536
    s_add_u32 s64, s64, s57
    buffer_load_dwordx4 v4, s[28:31], s64 offen lds
    v_mfma_f32_32x32x16_bf16 v[112:127], v[48:51], v[16:19], v[112:127]
    s_add_u32 m0, s49, 1024
    s_nop 0
    buffer_load_dwordx4 v5, s[28:31], s64 offen lds
    s_waitcnt vmcnt(8)
    v_mfma_f32_32x32x16_bf16 v[64:79], v[52:55], v[20:23], v[64:79]
    ds_read_b64_tr_b16 v[12:13], v8 offset:2048
    ds_read_b64_tr_b16 v[14:15], v8 offset:3072
    ds_read_b64_tr_b16 v[16:17], v9 offset:2048
    ds_read_b64_tr_b16 v[18:19], v9 offset:3072
    s_add_u32 s65, s63, 2
    s_and_b32 s65, s65, 3
    s_add_u32 s65, s65, 4
    s_mul_i32 s65, s65, 16384
    s_add_u32 s65, s65, s58
    buffer_load_dwordx4 v[44:47], v6, s[32:35], s65 offen sc1
    v_mfma_f32_32x32x16_bf16 v[80:95], v[52:55], v[24:27], v[80:95]
    buffer_load_dwordx4 v[48:51], v7, s[32:35], s65 offen sc1
    v_mfma_f32_32x32x16_bf16 v[96:111], v[56:59], v[20:23], v[96:111]
    s_waitcnt lgkmcnt(0)
    s_add_u32 m0, s49, 2048
    s_add_u32 s64, s63, 3
    s_and_b32 s64, s64, 3
    s_add_u32 s64, s64, 4
    s_mul_i32 s64, s64, 65536
    s_add_u32 s64, s64, s57
    buffer_load_dwordx4 v4, s[28:31], s64 offen lds
    v_mfma_f32_32x32x16_bf16 v[112:127], v[56:59], v[24:27], v[112:127]
    s_add_u32 m0, s49, 3072
    s_nop 0
    buffer_load_dwordx4 v5, s[28:31], s64 offen lds
    s_waitcnt vmcnt(8)
    v_mfma_f32_32x32x16_bf16 v[64:79], v[28:31], v[12:15], v[64:79]
    ds_read_b64_tr_b16 v[20:21], v8 offset:4096
    ds_read_b64_tr_b16 v[22:23], v8 offset:5120
    ds_read_b64_tr_b16 v[24:25], v9 offset:4096
    ds_read_b64_tr_b16 v[26:27], v9 offset:5120
    s_add_u32 s65, s63, 3
    s_and_b32 s65, s65, 3
    s_add_u32 s65, s65, 4
    s_mul_i32 s65, s65, 16384
    s_add_u32 s65, s65, s58
    buffer_load_dwordx4 v[52:55], v6, s[32:35], s65 offen sc1
    v_mfma_f32_32x32x16_bf16 v[80:95], v[28:31], v[16:19], v[80:95]
    buffer_load_dwordx4 v[56:59], v7, s[32:35], s65 offen sc1
    v_mfma_f32_32x32x16_bf16 v[96:111], v[32:35], v[12:15], v[96:111]
    s_waitcnt lgkmcnt(0)
    s_add_u32 m0, s49, 4096
    s_add_u32 s64, s63, 0
    s_and_b32 s64, s64, 3
    s_add_u32 s64, s64, 8
    s_mul_i32 s64, s64, 65536
    s_add_u32 s64, s64, s57
    buffer_load_dwordx4 v4, s[28:31], s64 offen lds
    v_mfma_f32_32x32x16_bf16 v[112:127], v[32:35], v[16:19], v[112:127]
    s_add_u32 m0, s49, 5120
    s_nop 0
    buffer_load_dwordx4 v5, s[28:31], s64 offen lds
    s_waitcnt vmcnt(8)
    v_mfma_f32_32x32x16_bf16 v[64:79], v[36:39], v[20:23], v[64:79]
    ds_read_b64_tr_b16 v[12:13], v8 offset:0
    ds_read_b64_tr_b16 v[14:15], v8 offset:1024
    ds_read_b64_tr_b16 v[16:17], v9 offset:0
    ds_read_b64_tr_b16 v[18:19], v9 offset:1024
    s_add_u32 s65, s63, 0
    s_and_b32 s65, s65, 3
    s_add_u32 s65, s65, 8
    s_mul_i32 s65, s65, 16384
    s_add_u32 s65, s65, s58
    buffer_load_dwordx4 v[28:31], v6, s[32:35], s65 offen sc1
    v_mfma_f32_32x32x16_bf16 v[80:95], v[36:39], v[24:27], v[80:95]
    buffer_load_dwordx4 v[32:35], v7, s[32:35], s65 offen sc1
    v_mfma_f32_32x32x16_bf16 v[96:111], v[40:43], v[20:23], v[96:111]
    s_waitcnt lgkmcnt(0)
    s_add_u32 m0, s49, 0
    s_add_u32 s64, s63, 1
    s_and_b32 s64, s64, 3
    s_add_u32 s64, s64, 8
    s_mul_i32 s64, s64, 65536
    s_add_u32 s64, s64, s57
    buffer_load_dwordx4 v4, s[28:31], s64 offen lds
    v_mfma_f32_32x32x16_bf16 v[112:127], v[40:43], v[24:27], v[112:127]
    s_add_u32 m0, s49, 1024
    s_nop 0
    buffer_load_dwordx4 v5, s[28:31], s64 offen lds
    s_waitcnt vmcnt(8)
    v_mfma_f32_32x32x16_bf16 v[64:79], v[44:47], v[12:15], v[64:79]
    ds_read_b64_tr_b16 v[20:21], v8 offset:2048
    ds_read_b64_tr_b16 v[22:23], v8 offset:3072
    ds_read_b64_tr_b16 v[24:25], v9 offset:2048
    ds_read_b64_tr_b16 v[26:27], v9 offset:3072
    s_add_u32 s65, s63, 1
    s_and_b32 s65, s65, 3
    s_add_u32 s65, s65, 8
    s_mul_i32 s65, s65, 16384
    s_add_u32 s65, s65, s58
    buffer_load_dwordx4 v[36:39], v6, s[32:35], s65 offen sc1
    v_mfma_f32_32x32x16_bf16 v[80:95], v[44:47], v[16:19], v[80:95]
    buffer_load_dwordx4 v[40:43], v7, s[32:35], s65 offen sc1
    v_mfma_f32_32x32x16_bf16 v[96:111], v[48:51], v[12:15], v[96:111]
    s_waitcnt lgkmcnt(0)
    s_add_u32 m0, s49, 2048
    s_add_u32 s64, s63, 2
    s_and_b32 s64, s64, 3
    s_add_u32 s64, s64, 8
    s_mul_i32 s64, s64, 65536
    s_add_u32 s64, s64, s57
    buffer_load_dwordx4 v4, s[28:31], s64 offen lds
    v_mfma_f32_32x32x16_bf16 v[112:127], v[48:51], v[16:19], v[112:127]
    s_add_u32 m0, s49, 3072
    s_nop 0
    buffer_load_dwordx4 v5, s[28:31], s64 offen lds
    s_waitcnt vmcnt(8)
    v_mfma_f32_32x32x16_bf16 v[64:79], v[52:55], v[20:23], v[64:79]
    ds_read_b64_tr_b16 v[12:13], v8 offset:4096
    ds_read_b64_tr_b16 v[14:15], v8 offset:5120
    ds_read_b64_tr_b16 v[16:17], v9 offset:4096
    ds_read_b64_tr_b16 v[18:19], v9 offset:5120
    s_add_u32 s65, s63, 2
    s_and_b32 s65, s65, 3
    s_add_u32 s65, s65, 8
    s_mul_i32 s65, s65, 16384
    s_add_u32 s65, s65, s58
    buffer_load_dwordx4 v[44:47], v6, s[32:35], s65 offen sc1
    v_mfma_f32_32x32x16_bf16 v[80:95], v[52:55], v[24:27], v[80:95]
    buffer_load_dwordx4 v[48:51], v7, s[32:35], s65 offen sc1
    v_mfma_f32_32x32x16_bf16 v[96:111], v[56:59], v[20:23], v[96:111]
    s_waitcnt lgkmcnt(0)
    s_add_u32 m0, s49, 4096
    s_add_u32 s64, s63, 3
    s_and_b32 s64, s64, 3
    s_add_u32 s64, s64, 8
    s_mul_i32 s64, s64, 65536
    s_add_u32 s64, s64, s57
    buffer_load_dwordx4 v4, s[28:31], s64 offen lds
    v_mfma_f32_32x32x16_bf16 v[112:127], v[56:59], v[24:27], v[112:127]
    s_add_u32 m0, s49, 5120
    s_nop 0
    buffer_load_dwordx4 v5, s[28:31], s64 offen lds
    s_waitcnt vmcnt(8)
    v_mfma_f32_32x32x16_bf16 v[64:79], v[28:31], v[12:15], v[64:79]
    ds_read_b64_tr_b16 v[20:21], v8 offset:0
    ds_read_b64_tr_b16 v[22:23], v8 offset:1024
    ds_read_b64_tr_b16 v[24:25], v9 offset:0
    ds_read_b64_tr_b16 v[26:27], v9 offset:1024
    s_add_u32 s65, s63, 3
    s_and_b32 s65, s65, 3
    s_add_u32 s65, s65, 8
    s_mul_i32 s65, s65, 16384
    s_add_u32 s65, s65, s58
    buffer_load_dwordx4 v[52:55], v6, s[32:35], s65 offen sc1
    v_mfma_f32_32x32x16_bf16 v[80:95], v[28:31], v[16:19], v[80:95]
    buffer_load_dwordx4 v[56:59], v7, s[32:35], s65 offen sc1
    v_mfma_f32_32x32x16_bf16 v[96:111], v[32:35], v[12:15], v[96:111]
    s_waitcnt lgkmcnt(0)
    s_add_u32 m0, s49, 0
    s_add_u32 s64, s63, 0
    s_and_b32 s64, s64, 3
    s_add_u32 s64, s64, 12
    s_mul_i32 s64, s64, 65536
    s_add_u32 s64, s64, s57
    buffer_load_dwordx4 v4, s[28:31], s64 offen lds
    v_mfma_f32_32x32x16_bf16 v[112:127], v[32:35], v[16:19], v[112:127]
    s_add_u32 m0, s49, 1024
    s_nop 0
    buffer_load_dwordx4 v5, s[28:31], s64 offen lds
    s_waitcnt vmcnt(8)
    v_mfma_f32_32x32x16_bf16 v[64:79], v[36:39], v[20:23], v[64:79]
    ds_read_b64_tr_b16 v[12:13], v8 offset:2048
    ds_read_b64_tr_b16 v[14:15], v8 offset:3072
    ds_read_b64_tr_b16 v[16:17], v9 offset:2048
    ds_read_b64_tr_b16 v[18:19], v9 offset:3072
    s_add_u32 s65, s63, 0
    s_and_b32 s65, s65, 3
    s_add_u32 s65, s65, 12
    s_mul_i32 s65, s65, 16384
    s_add_u32 s65, s65, s58
    buffer_load_dwordx4 v[28:31], v6, s[32:35], s65 offen sc1
    v_mfma_f32_32x32x16_bf16 v[80:95], v[36:39], v[24:27], v[80:95]
    buffer_load_dwordx4 v[32:35], v7, s[32:35], s65 offen sc1
    v_mfma_f32_32x32x16_bf16 v[96:111], v[40:43], v[20:23], v[96:111]
    s_waitcnt lgkmcnt(0)
    s_add_u32 m0, s49, 2048
    s_add_u32 s64, s63, 1
    s_and_b32 s64, s64, 3
    s_add_u32 s64, s64, 12
    s_mul_i32 s64, s64, 65536
    s_add_u32 s64, s64, s57
    buffer_load_dwordx4 v4, s[28:31], s64 offen lds
    v_mfma_f32_32x32x16_bf16 v[112:127], v[40:43], v[24:27], v[112:127]
    s_add_u32 m0, s49, 3072
    s_nop 0
    buffer_load_dwordx4 v5, s[28:31], s64 offen lds
    s_waitcnt vmcnt(8)
    v_mfma_f32_32x32x16_bf16 v[64:79], v[44:47], v[12:15], v[64:79]
    ds_read_b64_tr_b16 v[20:21], v8 offset:4096
    ds_read_b64_tr_b16 v[22:23], v8 offset:5120
    ds_read_b64_tr_b16 v[24:25], v9 offset:4096
    ds_read_b64_tr_b16 v[26:27], v9 offset:5120
    s_add_u32 s65, s63, 1
    s_and_b32 s65, s65, 3
    s_add_u32 s65, s65, 12
    s_mul_i32 s65, s65, 16384
    s_add_u32 s65, s65, s58
    buffer_load_dwordx4 v[36:39], v6, s[32:35], s65 offen sc1
    v_mfma_f32_32x32x16_bf16 v[80:95], v[44:47], v[16:19], v[80:95]
    buffer_load_dwordx4 v[40:43], v7, s[32:35], s65 offen sc1
    v_mfma_f32_32x32x16_bf16 v[96:111], v[48:51], v[12:15], v[96:111]
    s_waitcnt lgkmcnt(0)
    s_add_u32 m0, s49, 4096
    s_add_u32 s64, s63, 2
    s_and_b32 s64, s64, 3
    s_add_u32 s64, s64, 12
    s_mul_i32 s64, s64, 65536
    s_add_u32 s64, s64, s57
    buffer_load_dwordx4 v4, s[28:31], s64 offen lds
    v_mfma_f32_32x32x16_bf16 v[112:127], v[48:51], v[16:19], v[112:127]
    s_add_u32 m0, s49, 5120
    s_nop 0
    buffer_load_dwordx4 v5, s[28:31], s64 offen lds
    s_waitcnt vmcnt(8)
    v_mfma_f32_32x32x16_bf16 v[64:79], v[52:55], v[20:23], v[64:79]
    ds_read_b64_tr_b16 v[12:13], v8 offset:0
    ds_read_b64_tr_b16 v[14:15], v8 offset:1024
    ds_read_b64_tr_b16 v[16:17], v9 offset:0
    ds_read_b64_tr_b16 v[18:19], v9 offset:1024
    s_add_u32 s65, s63, 2
    s_and_b32 s65, s65, 3
    s_add_u32 s65, s65, 12
    s_mul_i32 s65, s65, 16384
    s_add_u32 s65, s65, s58
    buffer_load_dwordx4 v[44:47], v6, s[32:35], s65 offen sc1
    v_mfma_f32_32x32x16_bf16 v[80:95], v[52:55], v[24:27], v[80:95]
    buffer_load_dwordx4 v[48:51], v7, s[32:35], s65 offen sc1
    v_mfma_f32_32x32x16_bf16 v[96:111], v[56:59], v[20:23], v[96:111]
    s_waitcnt lgkmcnt(0)
    s_add_u32 m0, s49, 0
    s_add_u32 s64, s63, 3
    s_and_b32 s64, s64, 3
    s_add_u32 s64, s64, 12
    s_mul_i32 s64, s64, 65536
    s_add_u32 s64, s64, s57
    buffer_load_dwordx4 v4, s[28:31], s64 offen lds
    v_mfma_f32_32x32x16_bf16 v[112:127], v[56:59], v[24:27], v[112:127]
    s_add_u32 m0, s49, 1024
    s_nop 0
    buffer_load_dwordx4 v5, s[28:31], s64 offen lds
    s_waitcnt vmcnt(8)
    v_mfma_f32_32x32x16_bf16 v[64:79], v[28:31], v[12:15], v[64:79]
    ds_read_b64_tr_b16 v[20:21], v8 offset:2048
    ds_read_b64_tr_b16 v[22:23], v8 offset:3072
    ds_read_b64_tr_b16 v[24:25], v9 offset:2048
    ds_read_b64_tr_b16 v[26:27], v9 offset:3072
    s_add_u32 s65, s63, 3
    s_and_b32 s65, s65, 3
    s_add_u32 s65, s65, 12
    s_mul_i32 s65, s65, 16384
    s_add_u32 s65, s65, s58
    buffer_load_dwordx4 v[52:55], v6, s[32:35], s65 offen sc1
    v_mfma_f32_32x32x16_bf16 v[80:95], v[28:31], v[16:19], v[80:95]
    buffer_load_dwordx4 v[56:59], v7, s[32:35], s65 offen sc1
    v_mfma_f32_32x32x16_bf16 v[96:111], v[32:35], v[12:15], v[96:111]
    s_waitcnt lgkmcnt(0)
    s_add_u32 m0, s49, 2048
    s_add_u32 s64, s63, 0
    s_and_b32 s64, s64, 3
    s_add_u32 s64, s64, 16
    s_mul_i32 s64, s64, 65536
    s_add_u32 s64, s64, s57
    buffer_load_dwordx4 v4, s[28:31], s64 offen lds
    v_mfma_f32_32x32x16_bf16 v[112:127], v[32:35], v[16:19], v[112:127]
    s_add_u32 m0, s49, 3072
    s_nop 0
    buffer_load_dwordx4 v5, s[28:31], s64 offen lds
    s_waitcnt vmcnt(8)
    v_mfma_f32_32x32x16_bf16 v[64:79], v[36:39], v[20:23], v[64:79]
    ds_read_b64_tr_b16 v[12:13], v8 offset:4096
    ds_read_b64_tr_b16 v[14:15], v8 offset:5120
    ds_read_b64_tr_b16 v[16:17], v9 offset:4096
    ds_read_b64_tr_b16 v[18:19], v9 offset:5120
    s_add_u32 s65, s63, 0
    s_and_b32 s65, s65, 3
    s_add_u32 s65, s65, 16
    s_mul_i32 s65, s65, 16384
    s_add_u32 s65, s65, s58
    buffer_load_dwordx4 v[28:31], v6, s[32:35], s65 offen sc1
    v_mfma_f32_32x32x16_bf16 v[80:95], v[36:39], v[24:27], v[80:95]
    buffer_load_dwordx4 v[32:35], v7, s[32:35], s65 offen sc1
    v_mfma_f32_32x32x16_bf16 v[96:111], v[40:43], v[20:23], v[96:111]
    s_waitcnt lgkmcnt(0)
    s_add_u32 m0, s49, 4096
    s_add_u32 s64, s63, 1
    s_and_b32 s64, s64, 3
    s_add_u32 s64, s64, 16
    s_mul_i32 s64, s64, 65536
    s_add_u32 s64, s64, s57
    buffer_load_dwordx4 v4, s[28:31], s64 offen lds
    v_mfma_f32_32x32x16_bf16 v[112:127], v[40:43], v[24:27], v[112:127]
    s_add_u32 m0, s49, 5120
    s_nop 0
    buffer_load_dwordx4 v5, s[28:31], s64 offen lds
    s_waitcnt vmcnt(8)
    v_mfma_f32_32x32x16_bf16 v[64:79], v[44:47], v[12:15], v[64:79]
    ds_read_b64_tr_b16 v[20:21], v8 offset:0
    ds_read_b64_tr_b16 v[22:23], v8 offset:1024
    ds_read_b64_tr_b16 v[24:25], v9 offset:0
    ds_read_b64_tr_b16 v[26:27], v9 offset:1024
    s_add_u32 s65, s63, 1
    s_and_b32 s65, s65, 3
    s_add_u32 s65, s65, 16
    s_mul_i32 s65, s65, 16384
    s_add_u32 s65, s65, s58
    buffer_load_dwordx4 v[36:39], v6, s[32:35], s65 offen sc1
    v_mfma_f32_32x32x16_bf16 v[80:95], v[44:47], v[16:19], v[80:95]
    buffer_load_dwordx4 v[40:43], v7, s[32:35], s65 offen sc1
    v_mfma_f32_32x32x16_bf16 v[96:111], v[48:51], v[12:15], v[96:111]
    s_waitcnt lgkmcnt(0)
    s_add_u32 m0, s49, 0
    s_add_u32 s64, s63, 2
    s_and_b32 s64, s64, 3
    s_add_u32 s64, s64, 16
    s_mul_i32 s64, s64, 65536
    s_add_u32 s64, s64, s57
    buffer_load_dwordx4 v4, s[28:31], s64 offen lds
    v_mfma_f32_32x32x16_bf16 v[112:127], v[48:51], v[16:19], v[112:127]
    s_add_u32 m0, s49, 1024
    s_nop 0
    buffer_load_dwordx4 v5, s[28:31], s64 offen lds
    s_waitcnt vmcnt(8)
    v_mfma_f32_32x32x16_bf16 v[64:79], v[52:55], v[20:23], v[64:79]
    ds_read_b64_tr_b16 v[12:13], v8 offset:2048
    ds_read_b64_tr_b16 v[14:15], v8 offset:3072
    ds_read_b64_tr_b16 v[16:17], v9 offset:2048
    ds_read_b64_tr_b16 v[18:19], v9 offset:3072
    s_add_u32 s65, s63, 2
    s_and_b32 s65, s65, 3
    s_add_u32 s65, s65, 16
    s_mul_i32 s65, s65, 16384
    s_add_u32 s65, s65, s58
    buffer_load_dwordx4 v[44:47], v6, s[32:35], s65 offen sc1
    v_mfma_f32_32x32x16_bf16 v[80:95], v[52:55], v[24:27], v[80:95]
    buffer_load_dwordx4 v[48:51], v7, s[32:35], s65 offen sc1
    v_mfma_f32_32x32x16_bf16 v[96:111], v[56:59], v[20:23], v[96:111]
    s_waitcnt lgkmcnt(0)
    s_add_u32 m0, s49, 2048
    s_add_u32 s64, s63, 3
    s_and_b32 s64, s64, 3
    s_add_u32 s64, s64, 16
    s_mul_i32 s64, s64, 65536
    s_add_u32 s64, s64, s57
    buffer_load_dwordx4 v4, s[28:31], s64 offen lds
    v_mfma_f32_32x32x16_bf16 v[112:127], v[56:59], v[24:27], v[112:127]
    s_add_u32 m0, s49, 3072
    s_nop 0
    buffer_load_dwordx4 v5, s[28:31], s64 offen lds
    s_waitcnt vmcnt(8)
    v_mfma_f32_32x32x16_bf16 v[64:79], v[28:31], v[12:15], v[64:79]
    ds_read_b64_tr_b16 v[20:21], v8 offset:4096
    ds_read_b64_tr_b16 v[22:23], v8 offset:5120
    ds_read_b64_tr_b16 v[24:25], v9 offset:4096
    ds_read_b64_tr_b16 v[26:27], v9 offset:5120
    s_add_u32 s65, s63, 3
    s_and_b32 s65, s65, 3
    s_add_u32 s65, s65, 16
    s_mul_i32 s65, s65, 16384
    s_add_u32 s65, s65, s58
    buffer_load_dwordx4 v[52:55], v6, s[32:35], s65 offen sc1
    v_mfma_f32_32x32x16_bf16 v[80:95], v[28:31], v[16:19], v[80:95]
    buffer_load_dwordx4 v[56:59], v7, s[32:35], s65 offen sc1
    v_mfma_f32_32x32x16_bf16 v[96:111], v[32:35], v[12:15], v[96:111]
    s_waitcnt lgkmcnt(0)
    s_add_u32 m0, s49, 4096
    s_add_u32 s64, s63, 0
    s_and_b32 s64, s64, 1
    s_add_u32 s64, s64, 20
    s_mul_i32 s64, s64, 65536
    s_add_u32 s64, s64, s57
    buffer_load_dwordx4 v4, s[28:31], s64 offen lds
    v_mfma_f32_32x32x16_bf16 v[112:127], v[32:35], v[16:19], v[112:127]
    s_add_u32 m0, s49, 5120
    s_nop 0
    buffer_load_dwordx4 v5, s[28:31], s64 offen lds
    s_waitcnt vmcnt(8)
    v_mfma_f32_32x32x16_bf16 v[64:79], v[36:39], v[20:23], v[64:79]
    ds_read_b64_tr_b16 v[12:13], v8 offset:0
    ds_read_b64_tr_b16 v[14:15], v8 offset:1024
    ds_read_b64_tr_b16 v[16:17], v9 offset:0
    ds_read_b64_tr_b16 v[18:19], v9 offset:1024
    s_add_u32 s65, s63, 0
    s_and_b32 s65, s65, 1
    s_add_u32 s65, s65, 20
    s_mul_i32 s65, s65, 16384
    s_add_u32 s65, s65, s58
    buffer_load_dwordx4 v[28:31], v6, s[32:35], s65 offen sc1
    v_mfma_f32_32x32x16_bf16 v[80:95], v[36:39], v[24:27], v[80:95]
    buffer_load_dwordx4 v[32:35], v7, s[32:35], s65 offen sc1
    v_mfma_f32_32x32x16_bf16 v[96:111], v[40:43], v[20:23], v[96:111]
    s_waitcnt lgkmcnt(0)
    s_add_u32 m0, s49, 0
    s_add_u32 s64, s63, 1
    s_and_b32 s64, s64, 1
    s_add_u32 s64, s64, 20
    s_mul_i32 s64, s64, 65536
    s_add_u32 s64, s64, s57
    buffer_load_dwordx4 v4, s[28:31], s64 offen lds
    v_mfma_f32_32x32x16_bf16 v[112:127], v[40:43], v[24:27], v[112:127]
    s_add_u32 m0, s49, 1024
    s_nop 0
    buffer_load_dwordx4 v5, s[28:31], s64 offen lds
    s_waitcnt vmcnt(8)
    v_mfma_f32_32x32x16_bf16 v[64:79], v[44:47], v[12:15], v[64:79]
    ds_read_b64_tr_b16 v[20:21], v8 offset:2048
    ds_read_b64_tr_b16 v[22:23], v8 offset:3072
    ds_read_b64_tr_b16 v[24:25], v9 offset:2048
    ds_read_b64_tr_b16 v[26:27], v9 offset:3072
    s_add_u32 s65, s63, 1
    s_and_b32 s65, s65, 1
    s_add_u32 s65, s65, 20
    s_mul_i32 s65, s65, 16384
    s_add_u32 s65, s65, s58
    buffer_load_dwordx4 v[36:39], v6, s[32:35], s65 offen sc1
    v_mfma_f32_32x32x16_bf16 v[80:95], v[44:47], v[16:19], v[80:95]
    buffer_load_dwordx4 v[40:43], v7, s[32:35], s65 offen sc1
    v_mfma_f32_32x32x16_bf16 v[96:111], v[48:51], v[12:15], v[96:111]
    s_waitcnt lgkmcnt(0)
    v_mfma_f32_32x32x16_bf16 v[112:127], v[48:51], v[16:19], v[112:127]
    ds_write_b32 v136, v137 offset:160
    s_waitcnt vmcnt(6)
    v_mfma_f32_32x32x16_bf16 v[64:79], v[52:55], v[20:23], v[64:79]
    ds_read_b64_tr_b16 v[12:13], v8 offset:4096
    ds_read_b64_tr_b16 v[14:15], v8 offset:5120
    ds_read_b64_tr_b16 v[16:17], v9 offset:4096
    ds_read_b64_tr_b16 v[18:19], v9 offset:5120
    v_mfma_f32_32x32x16_bf16 v[80:95], v[52:55], v[24:27], v[80:95]
    v_mfma_f32_32x32x16_bf16 v[96:111], v[56:59], v[20:23], v[96:111]
    s_waitcnt lgkmcnt(0)
    v_mfma_f32_32x32x16_bf16 v[112:127], v[56:59], v[24:27], v[112:127]
    s_waitcnt vmcnt(2)
    v_mfma_f32_32x32x16_bf16 v[64:79], v[28:31], v[12:15], v[64:79]
    ds_read_b64_tr_b16 v[20:21], v8 offset:0
    ds_read_b64_tr_b16 v[22:23], v8 offset:1024
    ds_read_b64_tr_b16 v[24:25], v9 offset:0
    ds_read_b64_tr_b16 v[26:27], v9 offset:1024
    v_mfma_f32_32x32x16_bf16 v[80:95], v[28:31], v[16:19], v[80:95]
    v_mfma_f32_32x32x16_bf16 v[96:111], v[32:35], v[12:15], v[96:111]
    s_waitcnt lgkmcnt(0)
    v_mfma_f32_32x32x16_bf16 v[112:127], v[32:35], v[16:19], v[112:127]
    s_waitcnt vmcnt(0)
    v_mfma_f32_32x32x16_bf16 v[64:79], v[36:39], v[20:23], v[64:79]
    v_mfma_f32_32x32x16_bf16 v[80:95], v[36:39], v[24:27], v[80:95]
    v_mfma_f32_32x32x16_bf16 v[96:111], v[40:43], v[20:23], v[96:111]
    v_mfma_f32_32x32x16_bf16 v[112:127], v[40:43], v[24:27], v[112:127]
    s_setprio 3
    s_mov_b32 s28, s18
    s_mov_b32 s29, s19
    s_mov_b32 s30, 0x1000
    s_mov_b32 s31, 0x20000
    s_add_u32 s32, s26, 0xe00000
    s_addc_u32 s33, s27, 0
    s_mov_b32 s34, 0x2000
    s_mov_b32 s35, 0x20000
    s_lshl_b32 s61, s56, 7
    s_add_u32 s61, s61, s60
    s_lshl_b32 s62, s61, 1
    v_and_b32 v10, 31, v1
    v_lshlrev_b32 v11, 2, v10
    v_lshlrev_b32 v10, 1, v10
    buffer_load_ushort v28, v10, s[28:31], s61 offen
    buffer_load_dword v29, v11, s[32:35], s62 offen sc1
    v_lshlrev_b32 v10, 4, v1
    v_add_u32 v10, s49, v10
    v_mov_b32 v11, s49
    v_mov_b32 v129, 1
    s_nop 7
    ds_write_b128 v10, v[80:83] offset:0
    ds_write_b128 v10, v[84:87] offset:1024
    ds_write_b128 v10, v[88:91] offset:2048
    ds_write_b128 v10, v[92:95] offset:3072
    v_xor_b32 v131, 8192, v11
    s_waitcnt lgkmcnt(0)
    ds_write_b32 v11, v129 offset:6160
    s_mov_b32 s62, 0x100000
M2_R1:
    ds_read_b32 v128, v131 offset:6160
    s_waitcnt lgkmcnt(0)
    v_cmp_ne_u32 vcc, 1, v128
    s_sub_u32 s62, s62, 1
    s_cbranch_scc1 M2_R1_X
    s_cbranch_vccz M2_R1_X
    s_sleep 1
    s_branch M2_R1
M2_R1_X:
    v_xor_b32 v130, 8192, v10
    ds_read_b128 v[44:47], v130 offset:0
    ds_read_b128 v[48:51], v130 offset:1024
    ds_read_b128 v[52:55], v130 offset:2048
    ds_read_b128 v[56:59], v130 offset:3072
    s_waitcnt lgkmcnt(0)
    v_xor_b32 v130, 8192, v10
    ds_write_b128 v130, v[96:99] offset:0
    ds_write_b128 v130, v[100:103] offset:1024
    ds_write_b128 v130, v[104:107] offset:2048
    ds_write_b128 v130, v[108:111] offset:3072
    v_xor_b32 v131, 16384, v11
    v_pk_add_f32 v[64:65], v[64:65], v[44:45]
    v_pk_add_f32 v[66:67], v[66:67], v[46:47]
    v_pk_add_f32 v[68:69], v[68:69], v[48:49]
    v_pk_add_f32 v[70:71], v[70:71], v[50:51]
    v_pk_add_f32 v[72:73], v[72:73], v[52:53]
    v_pk_add_f32 v[74:75], v[74:75], v[54:55]
    v_pk_add_f32 v[76:77], v[76:77], v[56:57]
    v_pk_add_f32 v[78:79], v[78:79], v[58:59]
    s_waitcnt lgkmcnt(0)
    ds_write_b32 v11, v129 offset:6164
    s_mov_b32 s62, 0x100000
M2_R2:
    ds_read_b32 v128, v131 offset:6164
    s_waitcnt lgkmcnt(0)
    v_cmp_ne_u32 vcc, 1, v128
    s_sub_u32 s62, s62, 1
    s_cbranch_scc1 M2_R2_X
    s_cbranch_vccz M2_R2_X
    s_sleep 1
    s_branch M2_R2
M2_R2_X:
    v_xor_b32 v130, 24576, v10
    ds_read_b128 v[44:47], v130 offset:0
    ds_read_b128 v[48:51], v130 offset:1024
    ds_read_b128 v[52:55], v130 offset:2048
    ds_read_b128 v[56:59], v130 offset:3072
    s_waitcnt lgkmcnt(0)
    v_xor_b32 v130, 24576, v10
    ds_write_b128 v130, v[112:115] offset:0
    ds_write_b128 v130, v[116:119] offset:1024
    ds_write_b128 v130, v[120:123] offset:2048
    ds_write_b128 v130, v[124:127] offset:3072
    v_xor_b32 v131, 24576, v11
    v_pk_add_f32 v[64:65], v[64:65], v[44:45]
    v_pk_add_f32 v[66:67], v[66:67], v[46:47]
    v_pk_add_f32 v[68:69], v[68:69], v[48:49]
    v_pk_add_f32 v[70:71], v[70:71], v[50:51]
    v_pk_add_f32 v[72:73], v[72:73], v[52:53]
    v_pk_add_f32 v[74:75], v[74:75], v[54:55]
    v_pk_add_f32 v[76:77], v[76:77], v[56:57]
    v_pk_add_f32 v[78:79], v[78:79], v[58:59]
    s_waitcnt lgkmcnt(0)
    ds_write_b32 v11, v129 offset:6168
    s_mov_b32 s62, 0x100000
M2_R3:
    ds_read_b32 v128, v131 offset:6168
    s_waitcnt lgkmcnt(0)
    v_cmp_ne_u32 vcc, 1, v128
    s_sub_u32 s62, s62, 1
    s_cbranch_scc1 M2_R3_X
    s_cbranch_vccz M2_R3_X
    s_sleep 1
    s_branch M2_R3
M2_R3_X:
    ds_read_b128 v[44:47], v10 offset:0
    ds_read_b128 v[48:51], v10 offset:1024
    ds_read_b128 v[52:55], v10 offset:2048
    ds_read_b128 v[56:59], v10 offset:3072
    s_waitcnt lgkmcnt(0)
    v_pk_add_f32 v[64:65], v[64:65], v[44:45]
    v_pk_add_f32 v[66:67], v[66:67], v[46:47]
    v_pk_add_f32 v[68:69], v[68:69], v[48:49]
    v_pk_add_f32 v[70:71], v[70:71], v[50:51]
    v_pk_add_f32 v[72:73], v[72:73], v[52:53]
    v_pk_add_f32 v[74:75], v[74:75], v[54:55]
    v_pk_add_f32 v[76:77], v[76:77], v[56:57]
    v_pk_add_f32 v[78:79], v[78:79], v[58:59]
    s_waitcnt vmcnt(0)
    v_lshlrev_b32 v28, 16, v28
    v_sub_f32 v30, 1.0, v29
    v_mul_f32 v28, v28, v30
    v_fma_f32 v64, v64, v30, v28
    v_fma_f32 v65, v65, v30, v28
    v_fma_f32 v66, v66, v30, v28
    v_fma_f32 v67, v67, v30, v28
    v_fma_f32 v68, v68, v30, v28
    v_fma_f32 v69, v69, v30, v28
    v_fma_f32 v70, v70, v30, v28
    v_fma_f32 v71, v71, v30, v28
    v_fma_f32 v72, v72, v30, v28
    v_fma_f32 v73, v73, v30, v28
    v_fma_f32 v74, v74, v30, v28
    v_fma_f32 v75, v75, v30, v28
    v_fma_f32 v76, v76, v30, v28
    v_fma_f32 v77, v77, v30, v28
    v_fma_f32 v78, v78, v30, v28
    v_fma_f32 v79, v79, v30, v28
    s_lshl_b32 s60, s51, 6
    v_lshrrev_b32 v10, 5, v1
    v_mul_u32_u24 v10, 4, v10
    v_bfe_u32 v11, v1, 2, 2
    v_add_u32 v10, v10, v11
    v_lshlrev_b32 v10, 7, v10
    v_bfe_u32 v11, v1, 3, 1
    v_lshl_add_u32 v10, v11, 6, v10
    v_bfe_u32 v11, v1, 4, 1
    v_lshl_add_u32 v10, v11, 5, v10
    v_and_b32 v11, 3, v1
    v_lshl_add_u32 v10, v11, 3, v10
    v_xor_b32 v4, s60, v10
    s_lshl_b32 s60, s50, 10
    s_add_u32 s60, s60, 65536
    v_add_u32 v5, s60, v2
    s_mov_b32 s28, s22
    s_mov_b32 s29, s23
    s_mov_b32 s30, 0x200000
    s_mov_b32 s31, 0x20000
    v_and_b32 v9, 31, v1
    v_lshlrev_b32 v9, 10, v9
    v_lshrrev_b32 v10, 5, v1
    v_lshl_add_u32 v9, v10, 4, v9
    s_lshl_b32 s57, s56, 16
    s_lshl_b32 s58, s50, 15
    s_add_u32 s57, s57, s58
    s_lshl_b32 s58, s54, 7
    s_add_u32 s57, s57, s58
    s_lshl_b32 s58, s51, 6
    s_add_u32 s57, s57, s58
    s_barrier
    ds_read_b64_tr_b16 v[96:97], v4 offset:0
    ds_read_b64_tr_b16 v[98:99], v4 offset:1024
    ds_read_b128 v[128:131], v5 offset:0
    ds_read_b64_tr_b16 v[100:101], v4 offset:2048
    ds_read_b64_tr_b16 v[102:103], v4 offset:3072
    ds_read_b128 v[132:135], v5 offset:2048
    ds_read_b64_tr_b16 v[104:105], v4 offset:4096
    ds_read_b64_tr_b16 v[106:107], v4 offset:5120
    ds_read_b128 v[136:139], v5 offset:4096
    ds_read_b64_tr_b16 v[108:109], v4 offset:6144
    ds_read_b64_tr_b16 v[110:111], v4 offset:7168
    ds_read_b128 v[140:143], v5 offset:6144
    ds_read_b64_tr_b16 v[112:113], v4 offset:8192
    ds_read_b64_tr_b16 v[114:115], v4 offset:9216
    ds_read_b128 v[144:147], v5 offset:8192
    s_waitcnt lgkmcnt(12)
    v_mfma_f32_32x32x16_bf16 v[80:95], v[96:99], v[128:131], 0
    ds_read_b64_tr_b16 v[116:117], v4 offset:10240
    ds_read_b64_tr_b16 v[118:119], v4 offset:11264
    ds_read_b128 v[148:151], v5 offset:10240
    s_waitcnt lgkmcnt(12)
    v_mfma_f32_32x32x16_bf16 v[80:95], v[100:103], v[132:135], v[80:95]
    ds_read_b64_tr_b16 v[120:121], v4 offset:12288
    ds_read_b64_tr_b16 v[122:123], v4 offset:13312
    ds_read_b128 v[152:155], v5 offset:12288
    s_waitcnt lgkmcnt(12)
    v_mfma_f32_32x32x16_bf16 v[80:95], v[104:107], v[136:139], v[80:95]
    ds_read_b64_tr_b16 v[124:125], v4 offset:14336
    ds_read_b64_tr_b16 v[126:127], v4 offset:15360
    ds_read_b128 v[156:159], v5 offset:14336
    s_waitcnt lgkmcnt(12)
    v_mfma_f32_32x32x16_bf16 v[80:95], v[108:111], v[140:143], v[80:95]
    s_waitcnt lgkmcnt(9)
    v_mfma_f32_32x32x16_bf16 v[80:95], v[112:115], v[144:147], v[80:95]
    s_waitcnt lgkmcnt(6)
    v_mfma_f32_32x32x16_bf16 v[80:95], v[116:119], v[148:151], v[80:95]
    s_waitcnt lgkmcnt(3)
    v_mfma_f32_32x32x16_bf16 v[80:95], v[120:123], v[152:155], v[80:95]
    s_waitcnt lgkmcnt(0)
    v_mfma_f32_32x32x16_bf16 v[80:95], v[124:127], v[156:159], v[80:95]
    s_barrier
    ds_read_b64_tr_b16 v[96:97], v4 offset:16384
    ds_read_b64_tr_b16 v[98:99], v4 offset:17408
    ds_read_b128 v[128:131], v5 offset:16384
    ds_read_b64_tr_b16 v[100:101], v4 offset:18432
    ds_read_b64_tr_b16 v[102:103], v4 offset:19456
    ds_read_b128 v[132:135], v5 offset:18432
    ds_read_b64_tr_b16 v[104:105], v4 offset:20480
    ds_read_b64_tr_b16 v[106:107], v4 offset:21504
    ds_read_b128 v[136:139], v5 offset:20480
    ds_read_b64_tr_b16 v[108:109], v4 offset:22528
    ds_read_b64_tr_b16 v[110:111], v4 offset:23552
    ds_read_b128 v[140:143], v5 offset:22528
    ds_read_b64_tr_b16 v[112:113], v4 offset:24576
    ds_read_b64_tr_b16 v[114:115], v4 offset:25600
    ds_read_b128 v[144:147], v5 offset:24576
    s_waitcnt lgkmcnt(12)
    v_mfma_f32_32x32x16_bf16 v[80:95], v[96:99], v[128:131], v[80:95]
    ds_read_b64_tr_b16 v[116:117], v4 offset:26624
    ds_read_b64_tr_b16 v[118:119], v4 offset:27648
    ds_read_b128 v[148:151], v5 offset:26624
    s_waitcnt lgkmcnt(12)
    v_mfma_f32_32x32x16_bf16 v[80:95], v[100:103], v[132:135], v[80:95]
    ds_read_b64_tr_b16 v[120:121], v4 offset:28672
    ds_read_b64_tr_b16 v[122:123], v4 offset:29696
    ds_read_b128 v[152:155], v5 offset:28672
    s_waitcnt lgkmcnt(12)
    v_mfma_f32_32x32x16_bf16 v[80:95], v[104:107], v[136:139], v[80:95]
    ds_read_b64_tr_b16 v[124:125], v4 offset:30720
    ds_read_b64_tr_b16 v[126:127], v4 offset:31744
    ds_read_b128 v[156:159], v5 offset:30720
    s_waitcnt lgkmcnt(12)
    v_mfma_f32_32x32x16_bf16 v[80:95], v[108:111], v[140:143], v[80:95]
    s_waitcnt lgkmcnt(9)
    v_mfma_f32_32x32x16_bf16 v[80:95], v[112:115], v[144:147], v[80:95]
    s_waitcnt lgkmcnt(6)
    v_mfma_f32_32x32x16_bf16 v[80:95], v[116:119], v[148:151], v[80:95]
    s_waitcnt lgkmcnt(3)
    v_mfma_f32_32x32x16_bf16 v[80:95], v[120:123], v[152:155], v[80:95]
    s_waitcnt lgkmcnt(0)
    v_mfma_f32_32x32x16_bf16 v[80:95], v[124:127], v[156:159], v[80:95]
    s_barrier
    ds_read_b64_tr_b16 v[96:97], v4 offset:32768
    ds_read_b64_tr_b16 v[98:99], v4 offset:33792
    ds_read_b128 v[128:131], v5 offset:32768
    ds_read_b64_tr_b16 v[100:101], v4 offset:34816
    ds_read_b64_tr_b16 v[102:103], v4 offset:35840
    ds_read_b128 v[132:135], v5 offset:34816
    ds_read_b64_tr_b16 v[104:105], v4 offset:36864
    ds_read_b64_tr_b16 v[106:107], v4 offset:37888
    ds_read_b128 v[136:139], v5 offset:36864
    ds_read_b64_tr_b16 v[108:109], v4 offset:38912
    ds_read_b64_tr_b16 v[110:111], v4 offset:39936
    ds_read_b128 v[140:143], v5 offset:38912
    ds_read_b64_tr_b16 v[112:113], v4 offset:40960
    ds_read_b64_tr_b16 v[114:115], v4 offset:41984
    ds_read_b128 v[144:147], v5 offset:40960
    s_waitcnt lgkmcnt(12)
    v_mfma_f32_32x32x16_bf16 v[80:95], v[96:99], v[128:131], v[80:95]
    ds_read_b64_tr_b16 v[116:117], v4 offset:43008
    ds_read_b64_tr_b16 v[118:119], v4 offset:44032
    ds_read_b128 v[148:151], v5 offset:43008
    s_waitcnt lgkmcnt(12)
    v_mfma_f32_32x32x16_bf16 v[80:95], v[100:103], v[132:135], v[80:95]
    ds_read_b64_tr_b16 v[120:121], v4 offset:45056
    ds_read_b64_tr_b16 v[122:123], v4 offset:46080
    ds_read_b128 v[152:155], v5 offset:45056
    s_waitcnt lgkmcnt(12)
    v_mfma_f32_32x32x16_bf16 v[80:95], v[104:107], v[136:139], v[80:95]
    ds_read_b64_tr_b16 v[124:125], v4 offset:47104
    ds_read_b64_tr_b16 v[126:127], v4 offset:48128
    ds_read_b128 v[156:159], v5 offset:47104
    s_waitcnt lgkmcnt(12)
    v_mfma_f32_32x32x16_bf16 v[80:95], v[108:111], v[140:143], v[80:95]
    s_waitcnt lgkmcnt(9)
    v_mfma_f32_32x32x16_bf16 v[80:95], v[112:115], v[144:147], v[80:95]
    s_waitcnt lgkmcnt(6)
    v_mfma_f32_32x32x16_bf16 v[80:95], v[116:119], v[148:151], v[80:95]
    s_waitcnt lgkmcnt(3)
    v_mfma_f32_32x32x16_bf16 v[80:95], v[120:123], v[152:155], v[80:95]
    s_waitcnt lgkmcnt(0)
    v_mfma_f32_32x32x16_bf16 v[80:95], v[124:127], v[156:159], v[80:95]
    s_barrier
    ds_read_b64_tr_b16 v[96:97], v4 offset:49152
    ds_read_b64_tr_b16 v[98:99], v4 offset:50176
    ds_read_b128 v[128:131], v5 offset:49152
    ds_read_b64_tr_b16 v[100:101], v4 offset:51200
    ds_read_b64_tr_b16 v[102:103], v4 offset:52224
    ds_read_b128 v[132:135], v5 offset:51200
    ds_read_b64_tr_b16 v[104:105], v4 offset:53248
    ds_read_b64_tr_b16 v[106:107], v4 offset:54272
    ds_read_b128 v[136:139], v5 offset:53248
    ds_read_b64_tr_b16 v[108:109], v4 offset:55296
    ds_read_b64_tr_b16 v[110:111], v4 offset:56320
    ds_read_b128 v[140:143], v5 offset:55296
    ds_read_b64_tr_b16 v[112:113], v4 offset:57344
    ds_read_b64_tr_b16 v[114:115], v4 offset:58368
    ds_read_b128 v[144:147], v5 offset:57344
    s_waitcnt lgkmcnt(12)
    v_mfma_f32_32x32x16_bf16 v[80:95], v[96:99], v[128:131], v[80:95]
    ds_read_b64_tr_b16 v[116:117], v4 offset:59392
    ds_read_b64_tr_b16 v[118:119], v4 offset:60416
    ds_read_b128 v[148:151], v5 offset:59392
    s_waitcnt lgkmcnt(12)
    v_mfma_f32_32x32x16_bf16 v[80:95], v[100:103], v[132:135], v[80:95]
    ds_read_b64_tr_b16 v[120:121], v4 offset:61440
    ds_read_b64_tr_b16 v[122:123], v4 offset:62464
    ds_read_b128 v[152:155], v5 offset:61440
    s_waitcnt lgkmcnt(12)
    v_mfma_f32_32x32x16_bf16 v[80:95], v[104:107], v[136:139], v[80:95]
    ds_read_b64_tr_b16 v[124:125], v4 offset:63488
    ds_read_b64_tr_b16 v[126:127], v4 offset:64512
    ds_read_b128 v[156:159], v5 offset:63488
    s_waitcnt lgkmcnt(12)
    v_mfma_f32_32x32x16_bf16 v[80:95], v[108:111], v[140:143], v[80:95]
    s_waitcnt lgkmcnt(9)
    v_mfma_f32_32x32x16_bf16 v[80:95], v[112:115], v[144:147], v[80:95]
    s_waitcnt lgkmcnt(6)
    v_mfma_f32_32x32x16_bf16 v[80:95], v[116:119], v[148:151], v[80:95]
    s_waitcnt lgkmcnt(3)
    v_mfma_f32_32x32x16_bf16 v[80:95], v[120:123], v[152:155], v[80:95]
    s_waitcnt lgkmcnt(0)
    v_mfma_f32_32x32x16_bf16 v[80:95], v[124:127], v[156:159], v[80:95]
    s_nop 11
    v_fmac_f32 v64, v80, v29
    v_fmac_f32 v65, v81, v29
    v_fmac_f32 v66, v82, v29
    v_fmac_f32 v67, v83, v29
    v_fmac_f32 v68, v84, v29
    v_fmac_f32 v69, v85, v29
    v_fmac_f32 v70, v86, v29
    v_fmac_f32 v71, v87, v29
    v_fmac_f32 v72, v88, v29
    v_fmac_f32 v73, v89, v29
    v_fmac_f32 v74, v90, v29
    v_fmac_f32 v75, v91, v29
    v_fmac_f32 v76, v92, v29
    v_fmac_f32 v77, v93, v29
    v_fmac_f32 v78, v94, v29
    v_fmac_f32 v79, v95, v29
    v_cvt_pk_bf16_f32 v12, v64, v65
    v_cvt_pk_bf16_f32 v13, v66, v67
    v_cvt_pk_bf16_f32 v14, v68, v69
    v_cvt_pk_bf16_f32 v15, v70, v71
    v_cvt_pk_bf16_f32 v16, v72, v73
    v_cvt_pk_bf16_f32 v17, v74, v75
    v_cvt_pk_bf16_f32 v18, v76, v77
    v_cvt_pk_bf16_f32 v19, v78, v79
    v_permlane32_swap_b32 v12, v14
    v_permlane32_swap_b32 v13, v15
    buffer_store_dwordx4 v[12:15], v9, s[28:31], s57 offen offset:0
    v_permlane32_swap_b32 v16, v18
    v_permlane32_swap_b32 v17, v19
    buffer_store_dwordx4 v[16:19], v9, s[28:31], s57 offen offset:32
    s_endpgm
.section .rodata,"a"
.p2align 6
.amdhsa_kernel gated_mix__softmax_full_mha__mixer_token_mlp__prompt_kernel
  .amdhsa_next_free_vgpr 168
  .amdhsa_next_free_sgpr 70
  .amdhsa_accum_offset 168
  .amdhsa_group_segment_fixed_size 0
  .amdhsa_kernarg_size 96
  .amdhsa_user_sgpr_count 2
  .amdhsa_user_sgpr_kernarg_segment_ptr 1
  .amdhsa_system_sgpr_workgroup_id_x 1
.end_amdhsa_kernel
```
